```python
import torch

def _softmax(x, axis=-1):
    return torch.softmax(x, dim=axis)
def _gelu(x):
    return torch.nn.functional.gelu(x, approximate="tanh")
def _silu(x):
    return torch.nn.functional.silu(x)
def _sigmoid(x):
    return torch.sigmoid(x)
def _layernorm(x, axis=-1, eps=1e-5):
    m = x.mean(dim=axis, keepdim=True)
    v = x.var(dim=axis, keepdim=True, unbiased=False)
    return (x - m) / torch.sqrt(v + eps)
def _scatter_add(tgt, idx, src, axis=0):
    return tgt.clone().index_add_(axis, idx, src)
def _segment_sum(src, seg, n):
    out = torch.zeros((n,) + src.shape[1:], dtype=src.dtype)
    return out.index_add_(0, seg, src)
def _pad(x, pw):
    flat = tuple(v for pair in reversed(pw) for v in pair)
    return torch.nn.functional.pad(x, flat)

kernel_name = 'standalone__low_rank_proj_linformer__decode'

def setup_inputs():

    _w = (lambda a: (lambda t: t.to(torch.bfloat16) if t.is_floating_point() else t)(torch.as_tensor(a)))
    B, H, Sq, Skv, Dh, R = 4, 16, 1, 8192, 256, 64
    return {
        "q": _w((lambda *s: torch.randn(*s, dtype=torch.bfloat16) * 0.8)(B, H, Sq, Dh)),
        "k": _w((lambda *s: torch.randn(*s, dtype=torch.bfloat16) * 0.8)(B, H, Skv, Dh)),
        "v": _w((lambda *s: torch.randn(*s, dtype=torch.bfloat16) * 0.05)(B, H, Skv, Dh)),
        "e_proj": _w((lambda *s: torch.randn(*s, dtype=torch.bfloat16) * 0.8)(R, Skv) * (Skv ** -0.5)),
        "f_proj": _w((lambda *s: torch.randn(*s, dtype=torch.bfloat16) * 0.05)(R, Skv) * (Skv ** -0.5)),
    }

def reference(q, k, v, e_proj, f_proj):
    B, H, Sq, Dh = q.shape
    kp = torch.einsum("rn,bhnd->bhrd", e_proj, k)
    vp = torch.einsum("rn,bhnd->bhrd", f_proj, v)
    scores = torch.einsum("bhqd,bhrd->bhqr", q, kp) * (Dh ** -0.5)
    p = _softmax(scores, axis=-1)
    o = torch.einsum("bhqr,bhrd->bhqd", p, vp)
    return o
```

```asm
; @launch grid=(256,1,1) block=(384,1,1) lds=155904
.amdgcn_target "amdgcn-amd-amdhsa--gfx950"
.text
.globl standalone__low_rank_proj_linformer__decode_kernel
.p2align 8
.type standalone__low_rank_proj_linformer__decode_kernel,@function
standalone__low_rank_proj_linformer__decode_kernel:
  s_cmp_ge_u32 s2, 256
  s_cbranch_scc1 L_done
  s_load_dwordx16 s[4:19], s[0:1], 0
  s_mov_b32 s97, 0
  v_lshrrev_b32 v1, 6, v0
  v_and_b32 v2, 63, v0
  s_and_b32 s3, s2, 7
  s_lshr_b32 s24, s2, 3
  v_readfirstlane_b32 s20, v1
  s_and_b32 s21, s24, 15
  s_lshr_b32 s24, s24, 4
  s_lshl_b32 s24, s24, 3
  s_add_u32 s22, s24, s3
  s_lshl_b32 s23, s21, 2
  s_cmp_eq_u32 s20, 5
  s_cbranch_scc1 L_helper
  s_sub_u32 s20, s20, 1
  s_cbranch_scc0 L_consumer
  s_setprio 3
  v_lshlrev_b32 v3, 4, v2
  v_mov_b32 v4, 155648
  v_mov_b32 v6, 155664
  s_lshl_b32 s40, s23, 22
  s_lshl_b32 s41, s22, 18
  s_add_u32 s40, s40, s41
  s_waitcnt lgkmcnt(0)
  s_mov_b32 s24, s6
  s_and_b32 s25, s7, 0xffff
  s_mov_b32 s26, 268435456
  s_mov_b32 s27, 0x20000
  s_mov_b32 s32, s18
  s_and_b32 s33, s19, 0xffff
  s_mov_b32 s34, 8388608
  s_mov_b32 s35, 0x20000
  s_mov_b32 m0, 0
  s_add_u32 s48, s40, 0
  buffer_load_dwordx4 v3, s[24:27], s48 offen offset:0 nt lds
  buffer_load_dwordx4 v3, s[24:27], s48 offen offset:1024 nt lds
  buffer_load_dwordx4 v3, s[24:27], s48 offen offset:2048 nt lds
  buffer_load_dwordx4 v3, s[24:27], s48 offen offset:3072 nt lds
  s_mov_b32 m0, 4096
  s_add_u32 s48, s40, 4096
  buffer_load_dwordx4 v3, s[24:27], s48 offen offset:0 nt lds
  buffer_load_dwordx4 v3, s[24:27], s48 offen offset:1024 nt lds
  buffer_load_dwordx4 v3, s[24:27], s48 offen offset:2048 nt lds
  buffer_load_dwordx4 v3, s[24:27], s48 offen offset:3072 nt lds
  s_mov_b32 m0, 8192
  s_add_u32 s48, s40, 8192
  buffer_load_dwordx4 v3, s[24:27], s48 offen offset:0 nt lds
  buffer_load_dwordx4 v3, s[24:27], s48 offen offset:1024 nt lds
  buffer_load_dwordx4 v3, s[24:27], s48 offen offset:2048 nt lds
  buffer_load_dwordx4 v3, s[24:27], s48 offen offset:3072 nt lds
  s_mov_b32 m0, 12288
  s_add_u32 s48, s40, 12288
  buffer_load_dwordx4 v3, s[24:27], s48 offen offset:0 nt lds
  buffer_load_dwordx4 v3, s[24:27], s48 offen offset:1024 nt lds
  buffer_load_dwordx4 v3, s[24:27], s48 offen offset:2048 nt lds
  buffer_load_dwordx4 v3, s[24:27], s48 offen offset:3072 nt lds
  s_barrier
  s_mov_b32 s41, 0
  s_mov_b32 s60, 0
  ds_read_b128 v[8:11], v6
  s_mov_b32 s42, s40
  s_mov_b32 s43, 0
  s_mov_b32 s44, 0
  s_mov_b32 s45, -1
  s_branch L_lkg2
L_lk:
  s_lshr_b32 s42, s41, 3
  s_and_b32 s42, s42, 3
  s_lshl_b32 s42, s42, 22
  s_and_b32 s43, s41, 7
  s_lshl_b32 s43, s43, 15
  s_add_u32 s42, s42, s43
  s_add_u32 s42, s42, s40
  s_and_b32 s43, s41, 1
  s_lshl_b32 s43, s43, 15
  s_lshl_b32 s44, s41, 5
  s_sub_u32 s45, s41, 1
  s_waitcnt lgkmcnt(0)
  v_readfirstlane_b32 s50, v8
  s_cmp_ge_i32 s50, s45
  s_cbranch_scc1 L_lkc0_ok
L_lkc0:
  ds_read_b128 v[8:11], v6
  s_waitcnt lgkmcnt(0)
  v_readfirstlane_b32 s50, v8
  s_cmp_ge_i32 s50, s45
  s_cbranch_scc1 L_lkc0_ok
  s_add_u32 s60, s60, 1
  s_sleep 1
  s_add_u32 s97, s97, 1
  s_cmp_gt_u32 s97, 0x100000
  s_cbranch_scc1 L_done
  s_branch L_lkc0
L_lkc0_ok:
  ds_read_b128 v[8:11], v6
L_lkc0_ok2:
  s_add_u32 m0, s43, 0
  s_add_u32 s48, s42, 0
  s_waitcnt vmcnt(19)
  buffer_load_dwordx4 v3, s[24:27], s48 offen offset:0 nt lds
  s_waitcnt vmcnt(19)
  buffer_load_dwordx4 v3, s[24:27], s48 offen offset:1024 nt lds
  s_waitcnt vmcnt(19)
  buffer_load_dwordx4 v3, s[24:27], s48 offen offset:2048 nt lds
  s_waitcnt vmcnt(19)
  s_add_i32 s51, s44, -16
  v_mov_b32 v5, s51
  s_mov_b64 exec, 1
  ds_write_b32 v4, v5
  s_mov_b64 exec, -1
  buffer_load_dwordx4 v3, s[24:27], s48 offen offset:3072 nt lds
  s_add_u32 m0, s43, 4096
  s_add_u32 s48, s42, 4096
  s_waitcnt vmcnt(19)
  buffer_load_dwordx4 v3, s[24:27], s48 offen offset:0 nt lds
  s_waitcnt vmcnt(19)
  buffer_load_dwordx4 v3, s[24:27], s48 offen offset:1024 nt lds
  s_waitcnt vmcnt(19)
  buffer_load_dwordx4 v3, s[24:27], s48 offen offset:2048 nt lds
  s_waitcnt vmcnt(19)
  buffer_load_dwordx4 v3, s[24:27], s48 offen offset:3072 nt lds
  s_waitcnt lgkmcnt(0)
  v_readfirstlane_b32 s50, v9
  s_cmp_ge_i32 s50, s45
  s_cbranch_scc1 L_lkc1_ok
L_lkc1:
  ds_read_b128 v[8:11], v6
  s_waitcnt lgkmcnt(0)
  v_readfirstlane_b32 s50, v9
  s_cmp_ge_i32 s50, s45
  s_cbranch_scc1 L_lkc1_ok
  s_add_u32 s60, s60, 1
  s_sleep 1
  s_add_u32 s97, s97, 1
  s_cmp_gt_u32 s97, 0x100000
  s_cbranch_scc1 L_done
  s_branch L_lkc1
L_lkc1_ok:
  ds_read_b128 v[8:11], v6
L_lkc1_ok2:
  s_add_u32 m0, s43, 8192
  s_add_u32 s48, s42, 8192
  s_waitcnt vmcnt(19)
  buffer_load_dwordx4 v3, s[24:27], s48 offen offset:0 nt lds
  s_waitcnt vmcnt(19)
  buffer_load_dwordx4 v3, s[24:27], s48 offen offset:1024 nt lds
  s_waitcnt vmcnt(19)
  buffer_load_dwordx4 v3, s[24:27], s48 offen offset:2048 nt lds
  s_waitcnt vmcnt(19)
  s_add_i32 s51, s44, -8
  v_mov_b32 v5, s51
  s_mov_b64 exec, 1
  ds_write_b32 v4, v5
  s_mov_b64 exec, -1
  buffer_load_dwordx4 v3, s[24:27], s48 offen offset:3072 nt lds
  s_add_u32 m0, s43, 12288
  s_add_u32 s48, s42, 12288
  s_waitcnt vmcnt(19)
  buffer_load_dwordx4 v3, s[24:27], s48 offen offset:0 nt lds
  s_waitcnt vmcnt(19)
  buffer_load_dwordx4 v3, s[24:27], s48 offen offset:1024 nt lds
  s_waitcnt vmcnt(19)
  buffer_load_dwordx4 v3, s[24:27], s48 offen offset:2048 nt lds
  s_waitcnt vmcnt(19)
  buffer_load_dwordx4 v3, s[24:27], s48 offen offset:3072 nt lds
L_lkg2:
  s_waitcnt lgkmcnt(0)
  v_readfirstlane_b32 s50, v10
  s_cmp_ge_i32 s50, s45
  s_cbranch_scc1 L_lkc2_ok
L_lkc2:
  ds_read_b128 v[8:11], v6
  s_waitcnt lgkmcnt(0)
  v_readfirstlane_b32 s50, v10
  s_cmp_ge_i32 s50, s45
  s_cbranch_scc1 L_lkc2_ok
  s_add_u32 s60, s60, 1
  s_sleep 1
  s_add_u32 s97, s97, 1
  s_cmp_gt_u32 s97, 0x100000
  s_cbranch_scc1 L_done
  s_branch L_lkc2
L_lkc2_ok:
  ds_read_b128 v[8:11], v6
L_lkc2_ok2:
  s_add_u32 m0, s43, 16384
  s_add_u32 s48, s42, 16384
  s_waitcnt vmcnt(19)
  buffer_load_dwordx4 v3, s[24:27], s48 offen offset:0 nt lds
  s_waitcnt vmcnt(19)
  buffer_load_dwordx4 v3, s[24:27], s48 offen offset:1024 nt lds
  s_waitcnt vmcnt(19)
  buffer_load_dwordx4 v3, s[24:27], s48 offen offset:2048 nt lds
  s_waitcnt vmcnt(19)
  s_add_i32 s51, s44, 0
  v_mov_b32 v5, s51
  s_mov_b64 exec, 1
  ds_write_b32 v4, v5
  s_mov_b64 exec, -1
  buffer_load_dwordx4 v3, s[24:27], s48 offen offset:3072 nt lds
  s_add_u32 m0, s43, 20480
  s_add_u32 s48, s42, 20480
  s_waitcnt vmcnt(19)
  buffer_load_dwordx4 v3, s[24:27], s48 offen offset:0 nt lds
  s_waitcnt vmcnt(19)
  buffer_load_dwordx4 v3, s[24:27], s48 offen offset:1024 nt lds
  s_waitcnt vmcnt(19)
  buffer_load_dwordx4 v3, s[24:27], s48 offen offset:2048 nt lds
  s_waitcnt vmcnt(19)
  buffer_load_dwordx4 v3, s[24:27], s48 offen offset:3072 nt lds
  s_waitcnt lgkmcnt(0)
  v_readfirstlane_b32 s50, v11
  s_cmp_ge_i32 s50, s45
  s_cbranch_scc1 L_lkc3_ok
L_lkc3:
  ds_read_b128 v[8:11], v6
  s_waitcnt lgkmcnt(0)
  v_readfirstlane_b32 s50, v11
  s_cmp_ge_i32 s50, s45
  s_cbranch_scc1 L_lkc3_ok
  s_add_u32 s60, s60, 1
  s_sleep 1
  s_add_u32 s97, s97, 1
  s_cmp_gt_u32 s97, 0x100000
  s_cbranch_scc1 L_done
  s_branch L_lkc3
L_lkc3_ok:
  ds_read_b128 v[8:11], v6
L_lkc3_ok2:
  s_add_u32 m0, s43, 24576
  s_add_u32 s48, s42, 24576
  s_waitcnt vmcnt(19)
  buffer_load_dwordx4 v3, s[24:27], s48 offen offset:0 nt lds
  s_waitcnt vmcnt(19)
  buffer_load_dwordx4 v3, s[24:27], s48 offen offset:1024 nt lds
  s_waitcnt vmcnt(19)
  buffer_load_dwordx4 v3, s[24:27], s48 offen offset:2048 nt lds
  s_waitcnt vmcnt(19)
  s_add_i32 s51, s44, 8
  v_mov_b32 v5, s51
  s_mov_b64 exec, 1
  ds_write_b32 v4, v5
  s_mov_b64 exec, -1
  buffer_load_dwordx4 v3, s[24:27], s48 offen offset:3072 nt lds
  s_add_u32 m0, s43, 28672
  s_add_u32 s48, s42, 28672
  s_waitcnt vmcnt(19)
  buffer_load_dwordx4 v3, s[24:27], s48 offen offset:0 nt lds
  s_waitcnt vmcnt(19)
  buffer_load_dwordx4 v3, s[24:27], s48 offen offset:1024 nt lds
  s_waitcnt vmcnt(19)
  buffer_load_dwordx4 v3, s[24:27], s48 offen offset:2048 nt lds
  s_waitcnt vmcnt(19)
  buffer_load_dwordx4 v3, s[24:27], s48 offen offset:3072 nt lds
  s_add_u32 s41, s41, 1
  s_cmp_lt_u32 s41, 32
  s_cbranch_scc1 L_lk
  s_mov_b32 s24, s8
  s_and_b32 s25, s9, 0xffff
L_lv:
  s_lshr_b32 s42, s41, 3
  s_and_b32 s42, s42, 3
  s_lshl_b32 s42, s42, 22
  s_and_b32 s43, s41, 7
  s_lshl_b32 s43, s43, 15
  s_add_u32 s42, s42, s43
  s_add_u32 s42, s42, s40
  s_and_b32 s43, s41, 1
  s_lshl_b32 s43, s43, 15
  s_lshl_b32 s44, s41, 5
  s_sub_u32 s45, s41, 1
  v_mov_b32 v5, s41
  s_mov_b64 exec, 1
  ds_write_b32 v4, v5 offset:8
  s_mov_b64 exec, -1
  s_waitcnt lgkmcnt(0)
  v_readfirstlane_b32 s50, v8
  s_cmp_ge_i32 s50, s45
  s_cbranch_scc1 L_lvc0_ok
L_lvc0:
  ds_read_b128 v[8:11], v6
  s_waitcnt lgkmcnt(0)
  v_readfirstlane_b32 s50, v8
  s_cmp_ge_i32 s50, s45
  s_cbranch_scc1 L_lvc0_ok
  s_add_u32 s60, s60, 1
  s_sleep 1
  s_add_u32 s97, s97, 1
  s_cmp_gt_u32 s97, 0x100000
  s_cbranch_scc1 L_done
  s_branch L_lvc0
L_lvc0_ok:
  ds_read_b128 v[8:11], v6
L_lvc0_ok2:
  s_add_u32 m0, s43, 0
  s_add_u32 s48, s42, 0
  s_waitcnt vmcnt(19)
  buffer_load_dwordx4 v3, s[24:27], s48 offen offset:0 nt lds
  s_waitcnt vmcnt(19)
  buffer_load_dwordx4 v3, s[24:27], s48 offen offset:1024 nt lds
  s_waitcnt vmcnt(19)
  buffer_load_dwordx4 v3, s[24:27], s48 offen offset:2048 nt lds
  s_waitcnt vmcnt(19)
  s_add_i32 s51, s44, -16
  v_mov_b32 v5, s51
  s_mov_b64 exec, 1
  ds_write_b32 v4, v5
  s_mov_b64 exec, -1
  buffer_load_dwordx4 v3, s[24:27], s48 offen offset:3072 nt lds
  s_add_u32 m0, s43, 4096
  s_add_u32 s48, s42, 4096
  s_waitcnt vmcnt(19)
  buffer_load_dwordx4 v3, s[24:27], s48 offen offset:0 nt lds
  s_waitcnt vmcnt(19)
  buffer_load_dwordx4 v3, s[24:27], s48 offen offset:1024 nt lds
  s_waitcnt vmcnt(19)
  buffer_load_dwordx4 v3, s[24:27], s48 offen offset:2048 nt lds
  s_waitcnt vmcnt(19)
  buffer_load_dwordx4 v3, s[24:27], s48 offen offset:3072 nt lds
  s_waitcnt lgkmcnt(0)
  v_readfirstlane_b32 s50, v9
  s_cmp_ge_i32 s50, s45
  s_cbranch_scc1 L_lvc1_ok
L_lvc1:
  ds_read_b128 v[8:11], v6
  s_waitcnt lgkmcnt(0)
  v_readfirstlane_b32 s50, v9
  s_cmp_ge_i32 s50, s45
  s_cbranch_scc1 L_lvc1_ok
  s_add_u32 s60, s60, 1
  s_sleep 1
  s_add_u32 s97, s97, 1
  s_cmp_gt_u32 s97, 0x100000
  s_cbranch_scc1 L_done
  s_branch L_lvc1
L_lvc1_ok:
  ds_read_b128 v[8:11], v6
L_lvc1_ok2:
  s_add_u32 m0, s43, 8192
  s_add_u32 s48, s42, 8192
  s_waitcnt vmcnt(19)
  buffer_load_dwordx4 v3, s[24:27], s48 offen offset:0 nt lds
  s_waitcnt vmcnt(19)
  buffer_load_dwordx4 v3, s[24:27], s48 offen offset:1024 nt lds
  s_waitcnt vmcnt(19)
  buffer_load_dwordx4 v3, s[24:27], s48 offen offset:2048 nt lds
  s_waitcnt vmcnt(19)
  s_add_i32 s51, s44, -8
  v_mov_b32 v5, s51
  s_mov_b64 exec, 1
  ds_write_b32 v4, v5
  s_mov_b64 exec, -1
  buffer_load_dwordx4 v3, s[24:27], s48 offen offset:3072 nt lds
  s_add_u32 m0, s43, 12288
  s_add_u32 s48, s42, 12288
  s_waitcnt vmcnt(19)
  buffer_load_dwordx4 v3, s[24:27], s48 offen offset:0 nt lds
  s_waitcnt vmcnt(19)
  buffer_load_dwordx4 v3, s[24:27], s48 offen offset:1024 nt lds
  s_waitcnt vmcnt(19)
  buffer_load_dwordx4 v3, s[24:27], s48 offen offset:2048 nt lds
  s_waitcnt vmcnt(19)
  buffer_load_dwordx4 v3, s[24:27], s48 offen offset:3072 nt lds
  s_waitcnt lgkmcnt(0)
  v_readfirstlane_b32 s50, v10
  s_cmp_ge_i32 s50, s45
  s_cbranch_scc1 L_lvc2_ok
L_lvc2:
  ds_read_b128 v[8:11], v6
  s_waitcnt lgkmcnt(0)
  v_readfirstlane_b32 s50, v10
  s_cmp_ge_i32 s50, s45
  s_cbranch_scc1 L_lvc2_ok
  s_add_u32 s60, s60, 1
  s_sleep 1
  s_add_u32 s97, s97, 1
  s_cmp_gt_u32 s97, 0x100000
  s_cbranch_scc1 L_done
  s_branch L_lvc2
L_lvc2_ok:
  ds_read_b128 v[8:11], v6
L_lvc2_ok2:
  s_add_u32 m0, s43, 16384
  s_add_u32 s48, s42, 16384
  s_waitcnt vmcnt(19)
  buffer_load_dwordx4 v3, s[24:27], s48 offen offset:0 nt lds
  s_waitcnt vmcnt(19)
  buffer_load_dwordx4 v3, s[24:27], s48 offen offset:1024 nt lds
  s_waitcnt vmcnt(19)
  buffer_load_dwordx4 v3, s[24:27], s48 offen offset:2048 nt lds
  s_waitcnt vmcnt(19)
  s_add_i32 s51, s44, 0
  v_mov_b32 v5, s51
  s_mov_b64 exec, 1
  ds_write_b32 v4, v5
  s_mov_b64 exec, -1
  buffer_load_dwordx4 v3, s[24:27], s48 offen offset:3072 nt lds
  s_add_u32 m0, s43, 20480
  s_add_u32 s48, s42, 20480
  s_waitcnt vmcnt(19)
  buffer_load_dwordx4 v3, s[24:27], s48 offen offset:0 nt lds
  s_waitcnt vmcnt(19)
  buffer_load_dwordx4 v3, s[24:27], s48 offen offset:1024 nt lds
  s_waitcnt vmcnt(19)
  buffer_load_dwordx4 v3, s[24:27], s48 offen offset:2048 nt lds
  s_waitcnt vmcnt(19)
  buffer_load_dwordx4 v3, s[24:27], s48 offen offset:3072 nt lds
  s_waitcnt lgkmcnt(0)
  v_readfirstlane_b32 s50, v11
  s_cmp_ge_i32 s50, s45
  s_cbranch_scc1 L_lvc3_ok
L_lvc3:
  ds_read_b128 v[8:11], v6
  s_waitcnt lgkmcnt(0)
  v_readfirstlane_b32 s50, v11
  s_cmp_ge_i32 s50, s45
  s_cbranch_scc1 L_lvc3_ok
  s_add_u32 s60, s60, 1
  s_sleep 1
  s_add_u32 s97, s97, 1
  s_cmp_gt_u32 s97, 0x100000
  s_cbranch_scc1 L_done
  s_branch L_lvc3
L_lvc3_ok:
  ds_read_b128 v[8:11], v6
L_lvc3_ok2:
  s_add_u32 m0, s43, 24576
  s_add_u32 s48, s42, 24576
  s_waitcnt vmcnt(19)
  buffer_load_dwordx4 v3, s[24:27], s48 offen offset:0 nt lds
  s_waitcnt vmcnt(19)
  buffer_load_dwordx4 v3, s[24:27], s48 offen offset:1024 nt lds
  s_waitcnt vmcnt(19)
  buffer_load_dwordx4 v3, s[24:27], s48 offen offset:2048 nt lds
  s_waitcnt vmcnt(19)
  s_add_i32 s51, s44, 8
  v_mov_b32 v5, s51
  s_mov_b64 exec, 1
  ds_write_b32 v4, v5
  s_mov_b64 exec, -1
  buffer_load_dwordx4 v3, s[24:27], s48 offen offset:3072 nt lds
  s_add_u32 m0, s43, 28672
  s_add_u32 s48, s42, 28672
  s_waitcnt vmcnt(19)
  buffer_load_dwordx4 v3, s[24:27], s48 offen offset:0 nt lds
  s_waitcnt vmcnt(19)
  buffer_load_dwordx4 v3, s[24:27], s48 offen offset:1024 nt lds
  s_waitcnt vmcnt(19)
  buffer_load_dwordx4 v3, s[24:27], s48 offen offset:2048 nt lds
  s_waitcnt vmcnt(19)
  buffer_load_dwordx4 v3, s[24:27], s48 offen offset:3072 nt lds
  s_add_u32 s41, s41, 1
  s_cmp_lt_u32 s41, 60
  s_cbranch_scc1 L_lv
  s_mov_b32 s52, 0
  s_add_u32 s53, s23, 3
  s_lshl_b32 s53, s53, 22
  s_add_u32 s53, s53, 131072
  s_mul_i32 s54, s21, 16384
  s_add_u32 s54, s54, 2097152
L_lp:
  v_mov_b32 v5, s41
  s_mov_b64 exec, 1
  ds_write_b32 v4, v5 offset:8
  s_mov_b64 exec, -1
  s_and_b32 s49, s52, 3
  s_lshl_b32 s49, s49, 3
  s_add_u32 s49, s49, 155744
  v_mov_b32 v7, s49
  s_add_u32 s52, s52, 1
L_lptk:
  ds_read_b64 v[14:15], v7
  s_waitcnt lgkmcnt(0)
  v_readfirstlane_b32 s55, v14
  v_readfirstlane_b32 s56, v15
  s_cmp_eq_u32 s56, s52
  s_cbranch_scc1 L_lptk_ok
  s_sleep 1
  s_add_u32 s97, s97, 1
  s_cmp_gt_u32 s97, 0x100000
  s_cbranch_scc1 L_done
  s_branch L_lptk
L_lptk_ok:
  s_cmp_ge_u32 s55, 64
  s_cbranch_scc1 L_lpend
  s_lshr_b32 s42, s55, 2
  s_lshl_b32 s42, s42, 18
  s_and_b32 s43, s55, 3
  s_lshl_b32 s43, s43, 15
  s_add_u32 s42, s42, s43
  s_add_u32 s42, s42, s53
  s_lshl_b32 s48, s55, 8
  s_add_u32 s48, s48, s54
  s_and_b32 s43, s41, 3
  s_lshl_b32 s43, s43, 8
  s_add_u32 m0, s43, 69632
  s_mov_b64 exec, 0xffff
  buffer_load_dwordx4 v3, s[32:35], s48 offen sc1 lds
  s_mov_b64 exec, -1
  s_and_b32 s43, s41, 1
  s_lshl_b32 s43, s43, 15
  s_lshl_b32 s44, s41, 5
  s_sub_u32 s45, s41, 1
  ds_read_b128 v[8:11], v6
  s_waitcnt lgkmcnt(0)
  v_readfirstlane_b32 s50, v8
  s_cmp_ge_i32 s50, s45
  s_cbranch_scc1 L_lqc0_ok
L_lqc0:
  ds_read_b128 v[8:11], v6
  s_waitcnt lgkmcnt(0)
  v_readfirstlane_b32 s50, v8
  s_cmp_ge_i32 s50, s45
  s_cbranch_scc1 L_lqc0_ok
  s_add_u32 s60, s60, 1
  s_sleep 1
  s_add_u32 s97, s97, 1
  s_cmp_gt_u32 s97, 0x100000
  s_cbranch_scc1 L_done
  s_branch L_lqc0
L_lqc0_ok:
  ds_read_b128 v[8:11], v6
L_lqc0_ok2:
  s_add_u32 m0, s43, 0
  s_add_u32 s48, s42, 0
  s_waitcnt vmcnt(19)
  buffer_load_dwordx4 v3, s[24:27], s48 offen offset:0 nt lds
  s_waitcnt vmcnt(19)
  buffer_load_dwordx4 v3, s[24:27], s48 offen offset:1024 nt lds
  s_waitcnt vmcnt(19)
  buffer_load_dwordx4 v3, s[24:27], s48 offen offset:2048 nt lds
  s_waitcnt vmcnt(19)
  s_add_i32 s51, s44, -16
  v_mov_b32 v5, s51
  s_mov_b64 exec, 1
  ds_write_b32 v4, v5
  s_mov_b64 exec, -1
  buffer_load_dwordx4 v3, s[24:27], s48 offen offset:3072 nt lds
  s_add_u32 m0, s43, 4096
  s_add_u32 s48, s42, 4096
  s_waitcnt vmcnt(19)
  buffer_load_dwordx4 v3, s[24:27], s48 offen offset:0 nt lds
  s_waitcnt vmcnt(19)
  buffer_load_dwordx4 v3, s[24:27], s48 offen offset:1024 nt lds
  s_waitcnt vmcnt(19)
  buffer_load_dwordx4 v3, s[24:27], s48 offen offset:2048 nt lds
  s_waitcnt vmcnt(19)
  buffer_load_dwordx4 v3, s[24:27], s48 offen offset:3072 nt lds
  s_waitcnt lgkmcnt(0)
  v_readfirstlane_b32 s50, v9
  s_cmp_ge_i32 s50, s45
  s_cbranch_scc1 L_lqc1_ok
L_lqc1:
  ds_read_b128 v[8:11], v6
  s_waitcnt lgkmcnt(0)
  v_readfirstlane_b32 s50, v9
  s_cmp_ge_i32 s50, s45
  s_cbranch_scc1 L_lqc1_ok
  s_add_u32 s60, s60, 1
  s_sleep 1
  s_add_u32 s97, s97, 1
  s_cmp_gt_u32 s97, 0x100000
  s_cbranch_scc1 L_done
  s_branch L_lqc1
L_lqc1_ok:
  ds_read_b128 v[8:11], v6
L_lqc1_ok2:
  s_add_u32 m0, s43, 8192
  s_add_u32 s48, s42, 8192
  s_waitcnt vmcnt(19)
  buffer_load_dwordx4 v3, s[24:27], s48 offen offset:0 nt lds
  s_waitcnt vmcnt(19)
  buffer_load_dwordx4 v3, s[24:27], s48 offen offset:1024 nt lds
  s_waitcnt vmcnt(19)
  buffer_load_dwordx4 v3, s[24:27], s48 offen offset:2048 nt lds
  s_waitcnt vmcnt(19)
  s_add_i32 s51, s44, -8
  v_mov_b32 v5, s51
  s_mov_b64 exec, 1
  ds_write_b32 v4, v5
  s_mov_b64 exec, -1
  buffer_load_dwordx4 v3, s[24:27], s48 offen offset:3072 nt lds
  s_add_u32 m0, s43, 12288
  s_add_u32 s48, s42, 12288
  s_waitcnt vmcnt(19)
  buffer_load_dwordx4 v3, s[24:27], s48 offen offset:0 nt lds
  s_waitcnt vmcnt(19)
  buffer_load_dwordx4 v3, s[24:27], s48 offen offset:1024 nt lds
  s_waitcnt vmcnt(19)
  buffer_load_dwordx4 v3, s[24:27], s48 offen offset:2048 nt lds
  s_waitcnt vmcnt(19)
  buffer_load_dwordx4 v3, s[24:27], s48 offen offset:3072 nt lds
  s_waitcnt lgkmcnt(0)
  v_readfirstlane_b32 s50, v10
  s_cmp_ge_i32 s50, s45
  s_cbranch_scc1 L_lqc2_ok
L_lqc2:
  ds_read_b128 v[8:11], v6
  s_waitcnt lgkmcnt(0)
  v_readfirstlane_b32 s50, v10
  s_cmp_ge_i32 s50, s45
  s_cbranch_scc1 L_lqc2_ok
  s_add_u32 s60, s60, 1
  s_sleep 1
  s_add_u32 s97, s97, 1
  s_cmp_gt_u32 s97, 0x100000
  s_cbranch_scc1 L_done
  s_branch L_lqc2
L_lqc2_ok:
  ds_read_b128 v[8:11], v6
L_lqc2_ok2:
  s_add_u32 m0, s43, 16384
  s_add_u32 s48, s42, 16384
  s_waitcnt vmcnt(19)
  buffer_load_dwordx4 v3, s[24:27], s48 offen offset:0 nt lds
  s_waitcnt vmcnt(19)
  buffer_load_dwordx4 v3, s[24:27], s48 offen offset:1024 nt lds
  s_waitcnt vmcnt(19)
  buffer_load_dwordx4 v3, s[24:27], s48 offen offset:2048 nt lds
  s_waitcnt vmcnt(19)
  s_add_i32 s51, s44, 0
  v_mov_b32 v5, s51
  s_mov_b64 exec, 1
  ds_write_b32 v4, v5
  s_mov_b64 exec, -1
  buffer_load_dwordx4 v3, s[24:27], s48 offen offset:3072 nt lds
  s_add_u32 m0, s43, 20480
  s_add_u32 s48, s42, 20480
  s_waitcnt vmcnt(19)
  buffer_load_dwordx4 v3, s[24:27], s48 offen offset:0 nt lds
  s_waitcnt vmcnt(19)
  buffer_load_dwordx4 v3, s[24:27], s48 offen offset:1024 nt lds
  s_waitcnt vmcnt(19)
  buffer_load_dwordx4 v3, s[24:27], s48 offen offset:2048 nt lds
  s_waitcnt vmcnt(19)
  buffer_load_dwordx4 v3, s[24:27], s48 offen offset:3072 nt lds
  s_waitcnt lgkmcnt(0)
  v_readfirstlane_b32 s50, v11
  s_cmp_ge_i32 s50, s45
  s_cbranch_scc1 L_lqc3_ok
L_lqc3:
  ds_read_b128 v[8:11], v6
  s_waitcnt lgkmcnt(0)
  v_readfirstlane_b32 s50, v11
  s_cmp_ge_i32 s50, s45
  s_cbranch_scc1 L_lqc3_ok
  s_add_u32 s60, s60, 1
  s_sleep 1
  s_add_u32 s97, s97, 1
  s_cmp_gt_u32 s97, 0x100000
  s_cbranch_scc1 L_done
  s_branch L_lqc3
L_lqc3_ok:
  ds_read_b128 v[8:11], v6
L_lqc3_ok2:
  s_add_u32 m0, s43, 24576
  s_add_u32 s48, s42, 24576
  s_waitcnt vmcnt(19)
  buffer_load_dwordx4 v3, s[24:27], s48 offen offset:0 nt lds
  s_waitcnt vmcnt(19)
  buffer_load_dwordx4 v3, s[24:27], s48 offen offset:1024 nt lds
  s_waitcnt vmcnt(19)
  buffer_load_dwordx4 v3, s[24:27], s48 offen offset:2048 nt lds
  s_waitcnt vmcnt(19)
  s_add_i32 s51, s44, 8
  v_mov_b32 v5, s51
  s_mov_b64 exec, 1
  ds_write_b32 v4, v5
  s_mov_b64 exec, -1
  buffer_load_dwordx4 v3, s[24:27], s48 offen offset:3072 nt lds
  s_add_u32 m0, s43, 28672
  s_add_u32 s48, s42, 28672
  s_waitcnt vmcnt(19)
  buffer_load_dwordx4 v3, s[24:27], s48 offen offset:0 nt lds
  s_waitcnt vmcnt(19)
  buffer_load_dwordx4 v3, s[24:27], s48 offen offset:1024 nt lds
  s_waitcnt vmcnt(19)
  buffer_load_dwordx4 v3, s[24:27], s48 offen offset:2048 nt lds
  s_waitcnt vmcnt(19)
  buffer_load_dwordx4 v3, s[24:27], s48 offen offset:3072 nt lds
  s_add_u32 s41, s41, 1
  s_branch L_lp
L_lpend:
  v_mov_b32 v5, s41
  s_mov_b64 exec, 1
  ds_write_b32 v4, v5 offset:4
  s_mov_b64 exec, -1
  s_lshl_b32 s44, s41, 5
  s_waitcnt vmcnt(16)
  s_add_i32 s51, s44, -16
  v_mov_b32 v5, s51
  s_mov_b64 exec, 1
  ds_write_b32 v4, v5
  s_mov_b64 exec, -1
  s_waitcnt vmcnt(8)
  s_add_i32 s51, s44, -8
  v_mov_b32 v5, s51
  s_mov_b64 exec, 1
  ds_write_b32 v4, v5
  s_mov_b64 exec, -1
  s_waitcnt vmcnt(0)
  s_add_i32 s51, s44, 0
  v_mov_b32 v5, s51
  s_mov_b64 exec, 1
  ds_write_b32 v4, v5
  s_mov_b64 exec, -1
  s_waitcnt lgkmcnt(0)
  s_branch L_done
L_consumer:
  v_and_b32 v169, 31, v2
  v_lshlrev_b32 v169, 4, v169
  s_lshl_b32 s41, s23, 9
  s_waitcnt lgkmcnt(0)
  s_mov_b32 s36, s4
  s_and_b32 s37, s5, 0xffff
  s_mov_b32 s38, 32768
  s_mov_b32 s39, 0x20000
  buffer_load_dwordx4 v[36:39], v169, s[36:39], s41 offen offset:0
  buffer_load_dwordx4 v[40:43], v169, s[36:39], s41 offen offset:512
  buffer_load_dwordx4 v[44:47], v169, s[36:39], s41 offen offset:1024
  buffer_load_dwordx4 v[48:51], v169, s[36:39], s41 offen offset:1536
  s_mov_b32 s32, s18
  s_and_b32 s33, s19, 0xffff
  s_mov_b32 s34, 8388608
  s_mov_b32 s35, 0x20000
  s_lshl_b32 s40, s20, 13
  v_lshlrev_b32 v160, 4, v2
  v_add_u32 v160, s40, v160
  v_lshrrev_b32 v174, 4, v2
  v_lshlrev_b32 v161, 11, v174
  v_and_b32 v169, 15, v2
  v_lshlrev_b32 v169, 4, v169
  v_add_u32 v161, v161, v169
  v_add_u32 v161, s40, v161
  v_lshlrev_b32 v174, 4, v174
  s_lshl_b32 s42, s20, 9
  s_add_u32 s42, s42, 132096
  v_and_b32 v162, 16, v2
  v_lshrrev_b32 v162, 2, v162
  v_and_b32 v169, 8, v2
  v_add_u32 v162, v162, v169
  v_and_b32 v169, 4, v2
  v_lshlrev_b32 v169, 2, v169
  v_add_u32 v162, v162, v169
  v_lshrrev_b32 v169, 5, v2
  v_lshlrev_b32 v169, 1, v169
  v_add_u32 v162, v162, v169
  v_add_u32 v162, s42, v162
  v_and_b32 v169, 1, v2
  v_lshlrev_b32 v163, 8, v169
  v_add_u32 v163, v163, v174
  v_add_u32 v163, s42, v163
  v_add_u32 v175, s42, v174
  s_lshl_b32 s43, s20, 8
  s_add_u32 s43, s43, 134144
  v_add_u32 v164, s43, v174
  v_lshrrev_b32 v166, 5, v2
  v_lshlrev_b32 v166, 9, v166
  v_and_b32 v169, 15, v2
  v_lshlrev_b32 v169, 5, v169
  v_add_u32 v166, v166, v169
  v_and_b32 v169, 16, v2
  v_lshrrev_b32 v169, 2, v169
  v_add_u32 v166, v166, v169
  s_lshl_b32 s43, s20, 10
  s_add_u32 s43, s43, 139264
  v_add_u32 v166, s43, v166
  v_mov_b32 v167, 155648
  s_lshl_b32 s43, s20, 2
  s_add_u32 s43, s43, 155664
  v_mov_b32 v168, s43
  v_mov_b32 v171, 1
  s_mov_b32 s55, 0xffff0000
  s_barrier
  s_waitcnt vmcnt(0)
  s_mov_b32 s41, 0
  s_lshl_b32 s44, s20, 3
  s_add_u32 s44, s44, 8
L_kunit:
L_kw:
  ds_read_b32 v169, v167
  s_waitcnt lgkmcnt(0)
  v_readfirstlane_b32 s50, v169
  s_cmp_ge_i32 s50, s44
  s_cbranch_scc1 L_kw_ok
  s_sleep 1
  s_add_u32 s97, s97, 1
  s_cmp_gt_u32 s97, 0x100000
  s_cbranch_scc1 L_done
  s_branch L_kw
L_kw_ok:
  s_and_b32 s45, s41, 1
  s_lshl_b32 s45, s45, 15
  v_add_u32 v170, s45, v160
  ds_read_b128 v[4:7], v170 offset:0
  ds_read_b128 v[8:11], v170 offset:1024
  ds_read_b128 v[12:15], v170 offset:2048
  ds_read_b128 v[16:19], v170 offset:3072
  ds_read_b128 v[20:23], v170 offset:4096
  ds_read_b128 v[24:27], v170 offset:5120
  ds_read_b128 v[28:31], v170 offset:6144
  ds_read_b128 v[32:35], v170 offset:7168
  s_waitcnt lgkmcnt(7)
  v_dot2_f32_bf16 v132, v4, v36, 0
  v_dot2_f32_bf16 v132, v5, v37, v132
  v_dot2_f32_bf16 v132, v6, v38, v132
  v_dot2_f32_bf16 v132, v7, v39, v132
  s_waitcnt lgkmcnt(6)
  v_dot2_f32_bf16 v133, v8, v36, 0
  v_dot2_f32_bf16 v133, v9, v37, v133
  v_dot2_f32_bf16 v133, v10, v38, v133
  v_dot2_f32_bf16 v133, v11, v39, v133
  s_waitcnt lgkmcnt(5)
  v_dot2_f32_bf16 v134, v12, v36, 0
  v_dot2_f32_bf16 v134, v13, v37, v134
  v_dot2_f32_bf16 v134, v14, v38, v134
  v_dot2_f32_bf16 v134, v15, v39, v134
  s_waitcnt lgkmcnt(4)
  v_dot2_f32_bf16 v135, v16, v36, 0
  v_dot2_f32_bf16 v135, v17, v37, v135
  v_dot2_f32_bf16 v135, v18, v38, v135
  v_dot2_f32_bf16 v135, v19, v39, v135
  s_waitcnt lgkmcnt(3)
  v_dot2_f32_bf16 v136, v20, v36, 0
  v_dot2_f32_bf16 v136, v21, v37, v136
  v_dot2_f32_bf16 v136, v22, v38, v136
  v_dot2_f32_bf16 v136, v23, v39, v136
  s_waitcnt lgkmcnt(2)
  v_dot2_f32_bf16 v137, v24, v36, 0
  v_dot2_f32_bf16 v137, v25, v37, v137
  v_dot2_f32_bf16 v137, v26, v38, v137
  v_dot2_f32_bf16 v137, v27, v39, v137
  s_waitcnt lgkmcnt(1)
  v_dot2_f32_bf16 v138, v28, v36, 0
  v_dot2_f32_bf16 v138, v29, v37, v138
  v_dot2_f32_bf16 v138, v30, v38, v138
  v_dot2_f32_bf16 v138, v31, v39, v138
  s_waitcnt lgkmcnt(0)
  s_add_u32 s45, s41, 1
  v_mov_b32 v169, s45
  s_mov_b64 exec, 1
  ds_write_b32 v168, v169
  s_mov_b64 exec, -1
  v_dot2_f32_bf16 v139, v32, v36, 0
  v_dot2_f32_bf16 v139, v33, v37, v139
  v_dot2_f32_bf16 v139, v34, v38, v139
  v_dot2_f32_bf16 v139, v35, v39, v139
  s_nop 0
  v_permlane16_swap_b32 v132, v133
  v_permlane16_swap_b32 v134, v135
  v_permlane16_swap_b32 v136, v137
  v_permlane16_swap_b32 v138, v139
  v_add_f32 v140, v132, v133
  v_add_f32 v141, v134, v135
  v_add_f32 v142, v136, v137
  v_add_f32 v143, v138, v139
  v_add_f32_dpp v144, v140, v140 row_ror:8 row_mask:0xf bank_mask:0x3
  v_add_f32_dpp v144, v141, v141 row_ror:8 row_mask:0xf bank_mask:0xc
  v_add_f32_dpp v145, v142, v142 row_ror:8 row_mask:0xf bank_mask:0x3
  v_add_f32_dpp v145, v143, v143 row_ror:8 row_mask:0xf bank_mask:0xc
  s_nop 0
  v_add_f32_dpp v146, v144, v144 row_half_mirror row_mask:0xf bank_mask:0x5
  v_add_f32_dpp v146, v145, v145 row_half_mirror row_mask:0xf bank_mask:0xa
  s_nop 1
  v_add_f32_dpp v146, v146, v146 quad_perm:[1,0,3,2] row_mask:0xf bank_mask:0xf
  s_nop 1
  v_add_f32_dpp v146, v146, v146 quad_perm:[2,3,0,1] row_mask:0xf bank_mask:0xf
  v_cvt_pk_bf16_f32 v144, v146, v146
  s_and_b32 s45, s41, 7
  s_lshl_b32 s46, s45, 5
  v_add_u32 v169, s46, v162
  v_lshlrev_b32 v145, 16, v144
  ds_write_b16 v169, v144
  v_sub_f32 v145, v146, v145
  v_cvt_pk_bf16_f32 v140, v145, v145
  ds_write_b16 v169, v140 offset:256
  s_cmp_eq_u32 s45, 7
  s_cbranch_scc0 L_knoend
  s_cmp_eq_u32 s41, 7
  s_cbranch_scc0 L_noE
  v_mov_b32 v172, 155728
L_wE:
  ds_read_b32 v169, v172
  s_waitcnt lgkmcnt(0)
  v_readfirstlane_b32 s50, v169
  s_cmp_ge_i32 s50, 1
  s_cbranch_scc1 L_wE_ok
  s_sleep 2
  s_add_u32 s97, s97, 1
  s_cmp_gt_u32 s97, 0x100000
  s_cbranch_scc1 L_done
  s_branch L_wE
L_wE_ok:
  v_and_b32 v169, 15, v2
  v_mul_u32_u24 v170, 1040, v169
  v_lshrrev_b32 v169, 5, v2
  v_lshlrev_b32 v169, 7, v169
  v_add_u32 v170, v170, v169
  v_and_b32 v169, 16, v2
  v_add_u32 v170, v170, v169
  s_lshl_b32 s45, s20, 5
  s_add_u32 s45, s45, 65536
  v_add_u32 v170, s45, v170
  ds_read_b128 v[52:55], v170 offset:0
  ds_read_b128 v[56:59], v170 offset:256
  ds_read_b128 v[60:63], v170 offset:512
  ds_read_b128 v[64:67], v170 offset:768
  s_waitcnt lgkmcnt(4)
  ds_read_b128 v[68:71], v170 offset:16640
  ds_read_b128 v[72:75], v170 offset:16896
  ds_read_b128 v[76:79], v170 offset:17152
  ds_read_b128 v[80:83], v170 offset:17408
  s_waitcnt lgkmcnt(4)
  ds_read_b128 v[84:87], v170 offset:33280
  ds_read_b128 v[88:91], v170 offset:33536
  ds_read_b128 v[92:95], v170 offset:33792
  ds_read_b128 v[96:99], v170 offset:34048
  s_waitcnt lgkmcnt(4)
  ds_read_b128 v[100:103], v170 offset:49920
  ds_read_b128 v[104:107], v170 offset:50176
  ds_read_b128 v[108:111], v170 offset:50432
  ds_read_b128 v[112:115], v170 offset:50688
  s_waitcnt lgkmcnt(4)
L_noE:
  s_waitcnt lgkmcnt(0)
  ds_read_b128 v[4:7], v163 offset:0
  ds_read_b128 v[8:11], v163 offset:64
  ds_read_b128 v[12:15], v163 offset:128
  ds_read_b128 v[16:19], v163 offset:192
  s_waitcnt lgkmcnt(3)
  v_mfma_f32_16x16x32_bf16 v[116:119], v[52:55], v[4:7], 0
  v_mfma_f32_16x16x32_bf16 v[120:123], v[68:71], v[4:7], 0
  v_mfma_f32_16x16x32_bf16 v[124:127], v[84:87], v[4:7], 0
  v_mfma_f32_16x16x32_bf16 v[128:131], v[100:103], v[4:7], 0
  s_waitcnt lgkmcnt(2)
  v_mfma_f32_16x16x32_bf16 v[116:119], v[56:59], v[8:11], v[116:119]
  v_mfma_f32_16x16x32_bf16 v[120:123], v[72:75], v[8:11], v[120:123]
  v_mfma_f32_16x16x32_bf16 v[124:127], v[88:91], v[8:11], v[124:127]
  v_mfma_f32_16x16x32_bf16 v[128:131], v[104:107], v[8:11], v[128:131]
  s_waitcnt lgkmcnt(1)
  v_mfma_f32_16x16x32_bf16 v[116:119], v[60:63], v[12:15], v[116:119]
  v_mfma_f32_16x16x32_bf16 v[120:123], v[76:79], v[12:15], v[120:123]
  v_mfma_f32_16x16x32_bf16 v[124:127], v[92:95], v[12:15], v[124:127]
  v_mfma_f32_16x16x32_bf16 v[128:131], v[108:111], v[12:15], v[128:131]
  s_waitcnt lgkmcnt(0)
  v_mfma_f32_16x16x32_bf16 v[116:119], v[64:67], v[16:19], v[116:119]
  v_mfma_f32_16x16x32_bf16 v[120:123], v[80:83], v[16:19], v[120:123]
  v_mfma_f32_16x16x32_bf16 v[124:127], v[96:99], v[16:19], v[124:127]
  v_mfma_f32_16x16x32_bf16 v[128:131], v[112:115], v[16:19], v[128:131]
  s_lshr_b32 s45, s41, 3
  s_lshl_b32 s48, s45, 10
  v_add_u32 v170, s48, v164
  s_lshl_b32 s48, s45, 2
  s_add_u32 s48, s48, 155680
  v_mov_b32 v172, s48
  s_nop 4
  v_add_f32_dpp v116, v116, v116 quad_perm:[1,0,3,2] row_mask:0xf bank_mask:0xf
  v_add_f32_dpp v117, v117, v117 quad_perm:[1,0,3,2] row_mask:0xf bank_mask:0xf
  v_add_f32_dpp v118, v118, v118 quad_perm:[1,0,3,2] row_mask:0xf bank_mask:0xf
  v_add_f32_dpp v119, v119, v119 quad_perm:[1,0,3,2] row_mask:0xf bank_mask:0xf
  v_add_f32_dpp v120, v120, v120 quad_perm:[1,0,3,2] row_mask:0xf bank_mask:0xf
  v_add_f32_dpp v121, v121, v121 quad_perm:[1,0,3,2] row_mask:0xf bank_mask:0xf
  v_add_f32_dpp v122, v122, v122 quad_perm:[1,0,3,2] row_mask:0xf bank_mask:0xf
  v_add_f32_dpp v123, v123, v123 quad_perm:[1,0,3,2] row_mask:0xf bank_mask:0xf
  v_add_f32_dpp v124, v124, v124 quad_perm:[1,0,3,2] row_mask:0xf bank_mask:0xf
  v_add_f32_dpp v125, v125, v125 quad_perm:[1,0,3,2] row_mask:0xf bank_mask:0xf
  v_add_f32_dpp v126, v126, v126 quad_perm:[1,0,3,2] row_mask:0xf bank_mask:0xf
  v_add_f32_dpp v127, v127, v127 quad_perm:[1,0,3,2] row_mask:0xf bank_mask:0xf
  v_add_f32_dpp v128, v128, v128 quad_perm:[1,0,3,2] row_mask:0xf bank_mask:0xf
  v_add_f32_dpp v129, v129, v129 quad_perm:[1,0,3,2] row_mask:0xf bank_mask:0xf
  v_add_f32_dpp v130, v130, v130 quad_perm:[1,0,3,2] row_mask:0xf bank_mask:0xf
  v_add_f32_dpp v131, v131, v131 quad_perm:[1,0,3,2] row_mask:0xf bank_mask:0xf
  s_mov_b32 s46, 0x00010001
  s_mov_b32 s47, 0x00010001
  s_mov_b64 exec, s[46:47]
  ds_write_b128 v170, v[116:119] offset:0
  ds_write_b128 v170, v[120:123] offset:64
  ds_write_b128 v170, v[124:127] offset:128
  ds_write_b128 v170, v[128:131] offset:192
  s_mov_b64 exec, -1
  s_waitcnt lgkmcnt(0)
  s_mov_b64 exec, 1
  ds_add_u32 v172, v171
  s_mov_b64 exec, -1
  v_mov_b32 v36, v40
  v_mov_b32 v37, v41
  v_mov_b32 v38, v42
  v_mov_b32 v39, v43
  v_mov_b32 v40, v44
  v_mov_b32 v41, v45
  v_mov_b32 v42, v46
  v_mov_b32 v43, v47
  v_mov_b32 v44, v48
  v_mov_b32 v45, v49
  v_mov_b32 v46, v50
  v_mov_b32 v47, v51
L_knoend:
  s_add_u32 s41, s41, 1
  s_add_u32 s44, s44, 32
  s_cmp_lt_u32 s41, 32
  s_cbranch_scc1 L_kunit
  v_mov_b32 v172, 155732
L_wF:
  ds_read_b32 v169, v172
  s_waitcnt lgkmcnt(0)
  v_readfirstlane_b32 s50, v169
  s_cmp_ge_i32 s50, 1
  s_cbranch_scc1 L_wF_ok
  s_sleep 2
  s_add_u32 s97, s97, 1
  s_cmp_gt_u32 s97, 0x100000
  s_cbranch_scc1 L_done
  s_branch L_wF
L_wF_ok:
  v_and_b32 v169, 15, v2
  v_lshrrev_b32 v169, 2, v169
  v_lshrrev_b32 v170, 4, v2
  v_lshl_add_u32 v170, v170, 3, v169
  v_mul_u32_u24 v170, 1040, v170
  v_and_b32 v169, 3, v2
  v_lshlrev_b32 v169, 3, v169
  v_add_u32 v170, v170, v169
  s_lshl_b32 s45, s20, 5
  s_add_u32 s45, s45, 65536
  v_add_u32 v170, s45, v170
  ds_read_b64_tr_b16 v[52:53], v170 offset:0
  ds_read_b64_tr_b16 v[54:55], v170 offset:4160
  ds_read_b64_tr_b16 v[56:57], v170 offset:33280
  ds_read_b64_tr_b16 v[58:59], v170 offset:37440
  ds_read_b64_tr_b16 v[60:61], v170 offset:128
  ds_read_b64_tr_b16 v[62:63], v170 offset:4288
  ds_read_b64_tr_b16 v[64:65], v170 offset:33408
  ds_read_b64_tr_b16 v[66:67], v170 offset:37568
  s_waitcnt lgkmcnt(4)
  ds_read_b64_tr_b16 v[68:69], v170 offset:256
  ds_read_b64_tr_b16 v[70:71], v170 offset:4416
  ds_read_b64_tr_b16 v[72:73], v170 offset:33536
  ds_read_b64_tr_b16 v[74:75], v170 offset:37696
  ds_read_b64_tr_b16 v[76:77], v170 offset:384
  ds_read_b64_tr_b16 v[78:79], v170 offset:4544
  ds_read_b64_tr_b16 v[80:81], v170 offset:33664
  ds_read_b64_tr_b16 v[82:83], v170 offset:37824
  s_waitcnt lgkmcnt(4)
  ds_read_b64_tr_b16 v[84:85], v170 offset:512
  ds_read_b64_tr_b16 v[86:87], v170 offset:4672
  ds_read_b64_tr_b16 v[88:89], v170 offset:33792
  ds_read_b64_tr_b16 v[90:91], v170 offset:37952
  ds_read_b64_tr_b16 v[92:93], v170 offset:640
  ds_read_b64_tr_b16 v[94:95], v170 offset:4800
  ds_read_b64_tr_b16 v[96:97], v170 offset:33920
  ds_read_b64_tr_b16 v[98:99], v170 offset:38080
  s_waitcnt lgkmcnt(4)
  ds_read_b64_tr_b16 v[100:101], v170 offset:768
  ds_read_b64_tr_b16 v[102:103], v170 offset:4928
  ds_read_b64_tr_b16 v[104:105], v170 offset:34048
  ds_read_b64_tr_b16 v[106:107], v170 offset:38208
  ds_read_b64_tr_b16 v[108:109], v170 offset:896
  ds_read_b64_tr_b16 v[110:111], v170 offset:5056
  ds_read_b64_tr_b16 v[112:113], v170 offset:34176
  ds_read_b64_tr_b16 v[114:115], v170 offset:38336
  s_waitcnt lgkmcnt(4)
  s_waitcnt lgkmcnt(0)
  v_mov_b32 v116, 0
  v_mov_b32 v117, 0
  v_mov_b32 v118, 0
  v_mov_b32 v119, 0
  v_mov_b32 v120, 0
  v_mov_b32 v121, 0
  v_mov_b32 v122, 0
  v_mov_b32 v123, 0
  v_mov_b32 v124, 0
  v_mov_b32 v125, 0
  v_mov_b32 v126, 0
  v_mov_b32 v127, 0
  v_mov_b32 v128, 0
  v_mov_b32 v129, 0
  v_mov_b32 v130, 0
  v_mov_b32 v131, 0
  s_mov_b32 s49, 0
L_vhead:
  s_lshl_b32 s48, s49, 2
  s_add_u32 s48, s48, 155712
  v_mov_b32 v172, s48
L_wP:
  ds_read_b32 v169, v172
  s_waitcnt lgkmcnt(0)
  v_readfirstlane_b32 s50, v169
  s_cmp_ge_i32 s50, 1
  s_cbranch_scc1 L_wP_ok
  s_sleep 2
  s_add_u32 s97, s97, 1
  s_cmp_gt_u32 s97, 0x100000
  s_cbranch_scc1 L_done
  s_branch L_wP
L_wP_ok:
  s_cmp_eq_u32 s49, 2
  s_cbranch_scc0 L_now3
  s_lshl_b32 s48, s20, 6
  s_add_u32 s48, s48, 65536
  v_add_u32 v170, s48, v174
  v_and_b32 v169, 1, v2
  v_lshlrev_b32 v169, 7, v169
  v_add_u32 v169, v169, v174
  v_add_u32 v169, 139008, v169
  ds_read_b128 v[148:151], v169
  ds_read_b128 v[152:155], v169 offset:64
  s_waitcnt lgkmcnt(0)
  v_mfma_f32_16x16x32_bf16 v[4:7], v[84:87], v[148:151], 0
  v_mfma_f32_16x16x32_bf16 v[8:11], v[92:95], v[148:151], 0
  v_mfma_f32_16x16x32_bf16 v[12:15], v[100:103], v[148:151], 0
  v_mfma_f32_16x16x32_bf16 v[16:19], v[108:111], v[148:151], 0
  v_mfma_f32_16x16x32_bf16 v[4:7], v[88:91], v[152:155], v[4:7]
  v_mfma_f32_16x16x32_bf16 v[8:11], v[96:99], v[152:155], v[8:11]
  v_mfma_f32_16x16x32_bf16 v[12:15], v[104:107], v[152:155], v[12:15]
  v_mfma_f32_16x16x32_bf16 v[16:19], v[112:115], v[152:155], v[16:19]
  s_nop 7
  s_nop 1
  v_add_f32_dpp v4, v4, v4 quad_perm:[1,0,3,2] row_mask:0xf bank_mask:0xf
  v_add_f32_dpp v5, v5, v5 quad_perm:[1,0,3,2] row_mask:0xf bank_mask:0xf
  v_add_f32_dpp v6, v6, v6 quad_perm:[1,0,3,2] row_mask:0xf bank_mask:0xf
  v_add_f32_dpp v7, v7, v7 quad_perm:[1,0,3,2] row_mask:0xf bank_mask:0xf
  v_add_f32_dpp v8, v8, v8 quad_perm:[1,0,3,2] row_mask:0xf bank_mask:0xf
  v_add_f32_dpp v9, v9, v9 quad_perm:[1,0,3,2] row_mask:0xf bank_mask:0xf
  v_add_f32_dpp v10, v10, v10 quad_perm:[1,0,3,2] row_mask:0xf bank_mask:0xf
  v_add_f32_dpp v11, v11, v11 quad_perm:[1,0,3,2] row_mask:0xf bank_mask:0xf
  v_add_f32_dpp v12, v12, v12 quad_perm:[1,0,3,2] row_mask:0xf bank_mask:0xf
  v_add_f32_dpp v13, v13, v13 quad_perm:[1,0,3,2] row_mask:0xf bank_mask:0xf
  v_add_f32_dpp v14, v14, v14 quad_perm:[1,0,3,2] row_mask:0xf bank_mask:0xf
  v_add_f32_dpp v15, v15, v15 quad_perm:[1,0,3,2] row_mask:0xf bank_mask:0xf
  v_add_f32_dpp v16, v16, v16 quad_perm:[1,0,3,2] row_mask:0xf bank_mask:0xf
  v_add_f32_dpp v17, v17, v17 quad_perm:[1,0,3,2] row_mask:0xf bank_mask:0xf
  v_add_f32_dpp v18, v18, v18 quad_perm:[1,0,3,2] row_mask:0xf bank_mask:0xf
  v_add_f32_dpp v19, v19, v19 quad_perm:[1,0,3,2] row_mask:0xf bank_mask:0xf
  s_mov_b32 s46, 0x00010001
  s_mov_b32 s47, 0x00010001
  s_mov_b64 exec, s[46:47]
  ds_write_b128 v170, v[4:7] offset:0
  ds_write_b128 v170, v[8:11] offset:256
  ds_write_b128 v170, v[12:15] offset:512
  ds_write_b128 v170, v[16:19] offset:768
  s_mov_b64 exec, -1
  v_mov_b32 v172, 155740
  s_waitcnt lgkmcnt(0)
  s_mov_b64 exec, 1
  ds_add_u32 v172, v171
  s_mov_b64 exec, -1
L_now3:
  s_lshl_b32 s48, s49, 8
  s_add_u32 s48, s48, 138240
  v_and_b32 v169, 1, v2
  v_lshlrev_b32 v169, 7, v169
  v_add_u32 v169, v169, v174
  v_add_u32 v169, s48, v169
  ds_read_b128 v[148:151], v169
  ds_read_b128 v[152:155], v169 offset:64
  s_waitcnt lgkmcnt(0)
  v_mfma_f32_16x16x32_bf16 v[4:7], v[52:55], v[148:151], 0
  v_mfma_f32_16x16x32_bf16 v[8:11], v[60:63], v[148:151], 0
  v_mfma_f32_16x16x32_bf16 v[12:15], v[68:71], v[148:151], 0
  v_mfma_f32_16x16x32_bf16 v[16:19], v[76:79], v[148:151], 0
  v_mfma_f32_16x16x32_bf16 v[20:23], v[84:87], v[148:151], 0
  v_mfma_f32_16x16x32_bf16 v[24:27], v[92:95], v[148:151], 0
  v_mfma_f32_16x16x32_bf16 v[28:31], v[100:103], v[148:151], 0
  v_mfma_f32_16x16x32_bf16 v[32:35], v[108:111], v[148:151], 0
  v_mfma_f32_16x16x32_bf16 v[4:7], v[56:59], v[152:155], v[4:7]
  v_mfma_f32_16x16x32_bf16 v[8:11], v[64:67], v[152:155], v[8:11]
  v_mfma_f32_16x16x32_bf16 v[12:15], v[72:75], v[152:155], v[12:15]
  v_mfma_f32_16x16x32_bf16 v[16:19], v[80:83], v[152:155], v[16:19]
  v_mfma_f32_16x16x32_bf16 v[20:23], v[88:91], v[152:155], v[20:23]
  v_mfma_f32_16x16x32_bf16 v[24:27], v[96:99], v[152:155], v[24:27]
  v_mfma_f32_16x16x32_bf16 v[28:31], v[104:107], v[152:155], v[28:31]
  v_mfma_f32_16x16x32_bf16 v[32:35], v[112:115], v[152:155], v[32:35]
  s_nop 7
  s_nop 1
  v_add_f32_dpp v4, v4, v4 quad_perm:[1,0,3,2] row_mask:0xf bank_mask:0xf
  v_add_f32_dpp v5, v5, v5 quad_perm:[1,0,3,2] row_mask:0xf bank_mask:0xf
  v_add_f32_dpp v6, v6, v6 quad_perm:[1,0,3,2] row_mask:0xf bank_mask:0xf
  v_add_f32_dpp v7, v7, v7 quad_perm:[1,0,3,2] row_mask:0xf bank_mask:0xf
  v_add_f32_dpp v8, v8, v8 quad_perm:[1,0,3,2] row_mask:0xf bank_mask:0xf
  v_add_f32_dpp v9, v9, v9 quad_perm:[1,0,3,2] row_mask:0xf bank_mask:0xf
  v_add_f32_dpp v10, v10, v10 quad_perm:[1,0,3,2] row_mask:0xf bank_mask:0xf
  v_add_f32_dpp v11, v11, v11 quad_perm:[1,0,3,2] row_mask:0xf bank_mask:0xf
  v_add_f32_dpp v12, v12, v12 quad_perm:[1,0,3,2] row_mask:0xf bank_mask:0xf
  v_add_f32_dpp v13, v13, v13 quad_perm:[1,0,3,2] row_mask:0xf bank_mask:0xf
  v_add_f32_dpp v14, v14, v14 quad_perm:[1,0,3,2] row_mask:0xf bank_mask:0xf
  v_add_f32_dpp v15, v15, v15 quad_perm:[1,0,3,2] row_mask:0xf bank_mask:0xf
  v_add_f32_dpp v16, v16, v16 quad_perm:[1,0,3,2] row_mask:0xf bank_mask:0xf
  v_add_f32_dpp v17, v17, v17 quad_perm:[1,0,3,2] row_mask:0xf bank_mask:0xf
  v_add_f32_dpp v18, v18, v18 quad_perm:[1,0,3,2] row_mask:0xf bank_mask:0xf
  v_add_f32_dpp v19, v19, v19 quad_perm:[1,0,3,2] row_mask:0xf bank_mask:0xf
  v_add_f32_dpp v20, v20, v20 quad_perm:[1,0,3,2] row_mask:0xf bank_mask:0xf
  v_add_f32_dpp v21, v21, v21 quad_perm:[1,0,3,2] row_mask:0xf bank_mask:0xf
  v_add_f32_dpp v22, v22, v22 quad_perm:[1,0,3,2] row_mask:0xf bank_mask:0xf
  v_add_f32_dpp v23, v23, v23 quad_perm:[1,0,3,2] row_mask:0xf bank_mask:0xf
  v_add_f32_dpp v24, v24, v24 quad_perm:[1,0,3,2] row_mask:0xf bank_mask:0xf
  v_add_f32_dpp v25, v25, v25 quad_perm:[1,0,3,2] row_mask:0xf bank_mask:0xf
  v_add_f32_dpp v26, v26, v26 quad_perm:[1,0,3,2] row_mask:0xf bank_mask:0xf
  v_add_f32_dpp v27, v27, v27 quad_perm:[1,0,3,2] row_mask:0xf bank_mask:0xf
  v_add_f32_dpp v28, v28, v28 quad_perm:[1,0,3,2] row_mask:0xf bank_mask:0xf
  v_add_f32_dpp v29, v29, v29 quad_perm:[1,0,3,2] row_mask:0xf bank_mask:0xf
  v_add_f32_dpp v30, v30, v30 quad_perm:[1,0,3,2] row_mask:0xf bank_mask:0xf
  v_add_f32_dpp v31, v31, v31 quad_perm:[1,0,3,2] row_mask:0xf bank_mask:0xf
  v_add_f32_dpp v32, v32, v32 quad_perm:[1,0,3,2] row_mask:0xf bank_mask:0xf
  v_add_f32_dpp v33, v33, v33 quad_perm:[1,0,3,2] row_mask:0xf bank_mask:0xf
  v_add_f32_dpp v34, v34, v34 quad_perm:[1,0,3,2] row_mask:0xf bank_mask:0xf
  v_add_f32_dpp v35, v35, v35 quad_perm:[1,0,3,2] row_mask:0xf bank_mask:0xf
  s_mov_b32 s46, 0x00010001
  s_mov_b32 s47, 0x00010001
  s_mov_b64 exec, s[46:47]
  ds_write_b128 v175, v[4:7] offset:0
  ds_write_b128 v175, v[8:11] offset:64
  ds_write_b128 v175, v[12:15] offset:128
  ds_write_b128 v175, v[16:19] offset:192
  ds_write_b128 v175, v[20:23] offset:256
  ds_write_b128 v175, v[24:27] offset:320
  ds_write_b128 v175, v[28:31] offset:384
  ds_write_b128 v175, v[32:35] offset:448
  s_mov_b64 exec, -1
  v_mov_b32 v165, v175
  s_waitcnt lgkmcnt(0)
L_vunit:
L_vw:
  ds_read_b32 v169, v167
  s_waitcnt lgkmcnt(0)
  v_readfirstlane_b32 s50, v169
  s_cmp_ge_i32 s50, s44
  s_cbranch_scc1 L_vw_ok
  s_sleep 1
  s_add_u32 s97, s97, 1
  s_cmp_gt_u32 s97, 0x100000
  s_cbranch_scc1 L_done
  s_branch L_vw
L_vw_ok:
  s_and_b32 s45, s41, 1
  s_lshl_b32 s45, s45, 15
  v_add_u32 v170, s45, v161
  ds_read_b128 v[156:159], v165
  ds_read_b128 v[4:7], v170 offset:0
  ds_read_b128 v[8:11], v170 offset:256
  ds_read_b128 v[12:15], v170 offset:512
  ds_read_b128 v[16:19], v170 offset:768
  ds_read_b128 v[20:23], v170 offset:1024
  ds_read_b128 v[24:27], v170 offset:1280
  ds_read_b128 v[28:31], v170 offset:1536
  ds_read_b128 v[32:35], v170 offset:1792
  s_waitcnt lgkmcnt(7)
  v_lshlrev_b32 v132, 16, v4
  v_and_b32 v133, s55, v4
  v_lshlrev_b32 v134, 16, v5
  v_and_b32 v135, s55, v5
  v_lshlrev_b32 v136, 16, v6
  v_and_b32 v137, s55, v6
  v_lshlrev_b32 v138, 16, v7
  v_and_b32 v139, s55, v7
  v_pk_fma_f32 v[116:117], v[132:133], v[156:157], v[116:117] op_sel_hi:[1,0,1]
  v_pk_fma_f32 v[118:119], v[134:135], v[156:157], v[118:119] op_sel_hi:[1,0,1]
  v_pk_fma_f32 v[120:121], v[136:137], v[156:157], v[120:121] op_sel_hi:[1,0,1]
  v_pk_fma_f32 v[122:123], v[138:139], v[156:157], v[122:123] op_sel_hi:[1,0,1]
  s_waitcnt lgkmcnt(6)
  v_lshlrev_b32 v132, 16, v8
  v_and_b32 v133, s55, v8
  v_lshlrev_b32 v134, 16, v9
  v_and_b32 v135, s55, v9
  v_lshlrev_b32 v136, 16, v10
  v_and_b32 v137, s55, v10
  v_lshlrev_b32 v138, 16, v11
  v_and_b32 v139, s55, v11
  v_pk_fma_f32 v[124:125], v[132:133], v[156:157], v[124:125] op_sel_hi:[1,0,1]
  v_pk_fma_f32 v[126:127], v[134:135], v[156:157], v[126:127] op_sel_hi:[1,0,1]
  v_pk_fma_f32 v[128:129], v[136:137], v[156:157], v[128:129] op_sel_hi:[1,0,1]
  v_pk_fma_f32 v[130:131], v[138:139], v[156:157], v[130:131] op_sel_hi:[1,0,1]
  s_waitcnt lgkmcnt(5)
  v_lshlrev_b32 v132, 16, v12
  v_and_b32 v133, s55, v12
  v_lshlrev_b32 v134, 16, v13
  v_and_b32 v135, s55, v13
  v_lshlrev_b32 v136, 16, v14
  v_and_b32 v137, s55, v14
  v_lshlrev_b32 v138, 16, v15
  v_and_b32 v139, s55, v15
  v_pk_fma_f32 v[116:117], v[132:133], v[156:157], v[116:117] op_sel:[0,1,0] op_sel_hi:[1,1,1]
  v_pk_fma_f32 v[118:119], v[134:135], v[156:157], v[118:119] op_sel:[0,1,0] op_sel_hi:[1,1,1]
  v_pk_fma_f32 v[120:121], v[136:137], v[156:157], v[120:121] op_sel:[0,1,0] op_sel_hi:[1,1,1]
  v_pk_fma_f32 v[122:123], v[138:139], v[156:157], v[122:123] op_sel:[0,1,0] op_sel_hi:[1,1,1]
  s_waitcnt lgkmcnt(4)
  v_lshlrev_b32 v132, 16, v16
  v_and_b32 v133, s55, v16
  v_lshlrev_b32 v134, 16, v17
  v_and_b32 v135, s55, v17
  v_lshlrev_b32 v136, 16, v18
  v_and_b32 v137, s55, v18
  v_lshlrev_b32 v138, 16, v19
  v_and_b32 v139, s55, v19
  v_pk_fma_f32 v[124:125], v[132:133], v[156:157], v[124:125] op_sel:[0,1,0] op_sel_hi:[1,1,1]
  v_pk_fma_f32 v[126:127], v[134:135], v[156:157], v[126:127] op_sel:[0,1,0] op_sel_hi:[1,1,1]
  v_pk_fma_f32 v[128:129], v[136:137], v[156:157], v[128:129] op_sel:[0,1,0] op_sel_hi:[1,1,1]
  v_pk_fma_f32 v[130:131], v[138:139], v[156:157], v[130:131] op_sel:[0,1,0] op_sel_hi:[1,1,1]
  s_waitcnt lgkmcnt(3)
  v_lshlrev_b32 v132, 16, v20
  v_and_b32 v133, s55, v20
  v_lshlrev_b32 v134, 16, v21
  v_and_b32 v135, s55, v21
  v_lshlrev_b32 v136, 16, v22
  v_and_b32 v137, s55, v22
  v_lshlrev_b32 v138, 16, v23
  v_and_b32 v139, s55, v23
  v_pk_fma_f32 v[116:117], v[132:133], v[158:159], v[116:117] op_sel_hi:[1,0,1]
  v_pk_fma_f32 v[118:119], v[134:135], v[158:159], v[118:119] op_sel_hi:[1,0,1]
  v_pk_fma_f32 v[120:121], v[136:137], v[158:159], v[120:121] op_sel_hi:[1,0,1]
  v_pk_fma_f32 v[122:123], v[138:139], v[158:159], v[122:123] op_sel_hi:[1,0,1]
  s_waitcnt lgkmcnt(2)
  v_lshlrev_b32 v132, 16, v24
  v_and_b32 v133, s55, v24
  v_lshlrev_b32 v134, 16, v25
  v_and_b32 v135, s55, v25
  v_lshlrev_b32 v136, 16, v26
  v_and_b32 v137, s55, v26
  v_lshlrev_b32 v138, 16, v27
  v_and_b32 v139, s55, v27
  v_pk_fma_f32 v[124:125], v[132:133], v[158:159], v[124:125] op_sel_hi:[1,0,1]
  v_pk_fma_f32 v[126:127], v[134:135], v[158:159], v[126:127] op_sel_hi:[1,0,1]
  v_pk_fma_f32 v[128:129], v[136:137], v[158:159], v[128:129] op_sel_hi:[1,0,1]
  v_pk_fma_f32 v[130:131], v[138:139], v[158:159], v[130:131] op_sel_hi:[1,0,1]
  s_waitcnt lgkmcnt(1)
  v_lshlrev_b32 v132, 16, v28
  v_and_b32 v133, s55, v28
  v_lshlrev_b32 v134, 16, v29
  v_and_b32 v135, s55, v29
  v_lshlrev_b32 v136, 16, v30
  v_and_b32 v137, s55, v30
  v_lshlrev_b32 v138, 16, v31
  v_and_b32 v139, s55, v31
  v_pk_fma_f32 v[116:117], v[132:133], v[158:159], v[116:117] op_sel:[0,1,0] op_sel_hi:[1,1,1]
  v_pk_fma_f32 v[118:119], v[134:135], v[158:159], v[118:119] op_sel:[0,1,0] op_sel_hi:[1,1,1]
  v_pk_fma_f32 v[120:121], v[136:137], v[158:159], v[120:121] op_sel:[0,1,0] op_sel_hi:[1,1,1]
  v_pk_fma_f32 v[122:123], v[138:139], v[158:159], v[122:123] op_sel:[0,1,0] op_sel_hi:[1,1,1]
  s_waitcnt lgkmcnt(0)
  s_add_u32 s45, s41, 1
  v_mov_b32 v169, s45
  s_mov_b64 exec, 1
  ds_write_b32 v168, v169
  s_mov_b64 exec, -1
  v_lshlrev_b32 v132, 16, v32
  v_and_b32 v133, s55, v32
  v_lshlrev_b32 v134, 16, v33
  v_and_b32 v135, s55, v33
  v_lshlrev_b32 v136, 16, v34
  v_and_b32 v137, s55, v34
  v_lshlrev_b32 v138, 16, v35
  v_and_b32 v139, s55, v35
  v_pk_fma_f32 v[124:125], v[132:133], v[158:159], v[124:125] op_sel:[0,1,0] op_sel_hi:[1,1,1]
  v_pk_fma_f32 v[126:127], v[134:135], v[158:159], v[126:127] op_sel:[0,1,0] op_sel_hi:[1,1,1]
  v_pk_fma_f32 v[128:129], v[136:137], v[158:159], v[128:129] op_sel:[0,1,0] op_sel_hi:[1,1,1]
  v_pk_fma_f32 v[130:131], v[138:139], v[158:159], v[130:131] op_sel:[0,1,0] op_sel_hi:[1,1,1]
  v_add_u32 v165, 64, v165
  s_and_b32 s45, s41, 7
  s_add_u32 s41, s41, 1
  s_add_u32 s44, s44, 32
  s_cmp_eq_u32 s41, 60
  s_cbranch_scc1 L_vpool
  s_cmp_eq_u32 s45, 7
  s_cbranch_scc0 L_vunit
  s_branch L_vhend
L_vpool:
  s_lshl_b32 s48, s20, 6
  s_add_u32 s48, s48, 69632
  v_add_u32 v175, s48, v174
L_vpw:
  ds_read_b64 v[132:133], v167
  s_waitcnt lgkmcnt(0)
  v_readfirstlane_b32 s50, v132
  v_readfirstlane_b32 s51, v133
  s_cmp_ge_i32 s50, s44
  s_cbranch_scc1 L_vpw_ok
  s_cmp_eq_u32 s51, 0
  s_cbranch_scc1 L_vpw_sl
  s_cmp_ge_u32 s41, s51
  s_cbranch_scc1 L_vhend
L_vpw_sl:
  s_sleep 1
  s_add_u32 s97, s97, 1
  s_cmp_gt_u32 s97, 0x100000
  s_cbranch_scc1 L_done
  s_branch L_vpw
L_vpw_ok:
  s_and_b32 s45, s41, 1
  s_lshl_b32 s45, s45, 15
  v_add_u32 v170, s45, v161
  s_and_b32 s45, s41, 3
  s_lshl_b32 s45, s45, 8
  v_add_u32 v165, s45, v175
  ds_read_b128 v[156:159], v165
  ds_read_b128 v[4:7], v170 offset:0
  ds_read_b128 v[8:11], v170 offset:256
  ds_read_b128 v[12:15], v170 offset:512
  ds_read_b128 v[16:19], v170 offset:768
  ds_read_b128 v[20:23], v170 offset:1024
  ds_read_b128 v[24:27], v170 offset:1280
  ds_read_b128 v[28:31], v170 offset:1536
  ds_read_b128 v[32:35], v170 offset:1792
  s_waitcnt lgkmcnt(7)
  v_lshlrev_b32 v132, 16, v4
  v_and_b32 v133, s55, v4
  v_lshlrev_b32 v134, 16, v5
  v_and_b32 v135, s55, v5
  v_lshlrev_b32 v136, 16, v6
  v_and_b32 v137, s55, v6
  v_lshlrev_b32 v138, 16, v7
  v_and_b32 v139, s55, v7
  v_pk_fma_f32 v[116:117], v[132:133], v[156:157], v[116:117] op_sel_hi:[1,0,1]
  v_pk_fma_f32 v[118:119], v[134:135], v[156:157], v[118:119] op_sel_hi:[1,0,1]
  v_pk_fma_f32 v[120:121], v[136:137], v[156:157], v[120:121] op_sel_hi:[1,0,1]
  v_pk_fma_f32 v[122:123], v[138:139], v[156:157], v[122:123] op_sel_hi:[1,0,1]
  s_waitcnt lgkmcnt(6)
  v_lshlrev_b32 v132, 16, v8
  v_and_b32 v133, s55, v8
  v_lshlrev_b32 v134, 16, v9
  v_and_b32 v135, s55, v9
  v_lshlrev_b32 v136, 16, v10
  v_and_b32 v137, s55, v10
  v_lshlrev_b32 v138, 16, v11
  v_and_b32 v139, s55, v11
  v_pk_fma_f32 v[124:125], v[132:133], v[156:157], v[124:125] op_sel_hi:[1,0,1]
  v_pk_fma_f32 v[126:127], v[134:135], v[156:157], v[126:127] op_sel_hi:[1,0,1]
  v_pk_fma_f32 v[128:129], v[136:137], v[156:157], v[128:129] op_sel_hi:[1,0,1]
  v_pk_fma_f32 v[130:131], v[138:139], v[156:157], v[130:131] op_sel_hi:[1,0,1]
  s_waitcnt lgkmcnt(5)
  v_lshlrev_b32 v132, 16, v12
  v_and_b32 v133, s55, v12
  v_lshlrev_b32 v134, 16, v13
  v_and_b32 v135, s55, v13
  v_lshlrev_b32 v136, 16, v14
  v_and_b32 v137, s55, v14
  v_lshlrev_b32 v138, 16, v15
  v_and_b32 v139, s55, v15
  v_pk_fma_f32 v[116:117], v[132:133], v[156:157], v[116:117] op_sel:[0,1,0] op_sel_hi:[1,1,1]
  v_pk_fma_f32 v[118:119], v[134:135], v[156:157], v[118:119] op_sel:[0,1,0] op_sel_hi:[1,1,1]
  v_pk_fma_f32 v[120:121], v[136:137], v[156:157], v[120:121] op_sel:[0,1,0] op_sel_hi:[1,1,1]
  v_pk_fma_f32 v[122:123], v[138:139], v[156:157], v[122:123] op_sel:[0,1,0] op_sel_hi:[1,1,1]
  s_waitcnt lgkmcnt(4)
  v_lshlrev_b32 v132, 16, v16
  v_and_b32 v133, s55, v16
  v_lshlrev_b32 v134, 16, v17
  v_and_b32 v135, s55, v17
  v_lshlrev_b32 v136, 16, v18
  v_and_b32 v137, s55, v18
  v_lshlrev_b32 v138, 16, v19
  v_and_b32 v139, s55, v19
  v_pk_fma_f32 v[124:125], v[132:133], v[156:157], v[124:125] op_sel:[0,1,0] op_sel_hi:[1,1,1]
  v_pk_fma_f32 v[126:127], v[134:135], v[156:157], v[126:127] op_sel:[0,1,0] op_sel_hi:[1,1,1]
  v_pk_fma_f32 v[128:129], v[136:137], v[156:157], v[128:129] op_sel:[0,1,0] op_sel_hi:[1,1,1]
  v_pk_fma_f32 v[130:131], v[138:139], v[156:157], v[130:131] op_sel:[0,1,0] op_sel_hi:[1,1,1]
  s_waitcnt lgkmcnt(3)
  v_lshlrev_b32 v132, 16, v20
  v_and_b32 v133, s55, v20
  v_lshlrev_b32 v134, 16, v21
  v_and_b32 v135, s55, v21
  v_lshlrev_b32 v136, 16, v22
  v_and_b32 v137, s55, v22
  v_lshlrev_b32 v138, 16, v23
  v_and_b32 v139, s55, v23
  v_pk_fma_f32 v[116:117], v[132:133], v[158:159], v[116:117] op_sel_hi:[1,0,1]
  v_pk_fma_f32 v[118:119], v[134:135], v[158:159], v[118:119] op_sel_hi:[1,0,1]
  v_pk_fma_f32 v[120:121], v[136:137], v[158:159], v[120:121] op_sel_hi:[1,0,1]
  v_pk_fma_f32 v[122:123], v[138:139], v[158:159], v[122:123] op_sel_hi:[1,0,1]
  s_waitcnt lgkmcnt(2)
  v_lshlrev_b32 v132, 16, v24
  v_and_b32 v133, s55, v24
  v_lshlrev_b32 v134, 16, v25
  v_and_b32 v135, s55, v25
  v_lshlrev_b32 v136, 16, v26
  v_and_b32 v137, s55, v26
  v_lshlrev_b32 v138, 16, v27
  v_and_b32 v139, s55, v27
  v_pk_fma_f32 v[124:125], v[132:133], v[158:159], v[124:125] op_sel_hi:[1,0,1]
  v_pk_fma_f32 v[126:127], v[134:135], v[158:159], v[126:127] op_sel_hi:[1,0,1]
  v_pk_fma_f32 v[128:129], v[136:137], v[158:159], v[128:129] op_sel_hi:[1,0,1]
  v_pk_fma_f32 v[130:131], v[138:139], v[158:159], v[130:131] op_sel_hi:[1,0,1]
  s_waitcnt lgkmcnt(1)
  v_lshlrev_b32 v132, 16, v28
  v_and_b32 v133, s55, v28
  v_lshlrev_b32 v134, 16, v29
  v_and_b32 v135, s55, v29
  v_lshlrev_b32 v136, 16, v30
  v_and_b32 v137, s55, v30
  v_lshlrev_b32 v138, 16, v31
  v_and_b32 v139, s55, v31
  v_pk_fma_f32 v[116:117], v[132:133], v[158:159], v[116:117] op_sel:[0,1,0] op_sel_hi:[1,1,1]
  v_pk_fma_f32 v[118:119], v[134:135], v[158:159], v[118:119] op_sel:[0,1,0] op_sel_hi:[1,1,1]
  v_pk_fma_f32 v[120:121], v[136:137], v[158:159], v[120:121] op_sel:[0,1,0] op_sel_hi:[1,1,1]
  v_pk_fma_f32 v[122:123], v[138:139], v[158:159], v[122:123] op_sel:[0,1,0] op_sel_hi:[1,1,1]
  s_waitcnt lgkmcnt(0)
  s_add_u32 s45, s41, 1
  v_mov_b32 v169, s45
  s_mov_b64 exec, 1
  ds_write_b32 v168, v169
  s_mov_b64 exec, -1
  v_lshlrev_b32 v132, 16, v32
  v_and_b32 v133, s55, v32
  v_lshlrev_b32 v134, 16, v33
  v_and_b32 v135, s55, v33
  v_lshlrev_b32 v136, 16, v34
  v_and_b32 v137, s55, v34
  v_lshlrev_b32 v138, 16, v35
  v_and_b32 v139, s55, v35
  v_pk_fma_f32 v[124:125], v[132:133], v[158:159], v[124:125] op_sel:[0,1,0] op_sel_hi:[1,1,1]
  v_pk_fma_f32 v[126:127], v[134:135], v[158:159], v[126:127] op_sel:[0,1,0] op_sel_hi:[1,1,1]
  v_pk_fma_f32 v[128:129], v[136:137], v[158:159], v[128:129] op_sel:[0,1,0] op_sel_hi:[1,1,1]
  v_pk_fma_f32 v[130:131], v[138:139], v[158:159], v[130:131] op_sel:[0,1,0] op_sel_hi:[1,1,1]
  s_add_u32 s41, s41, 1
  s_add_u32 s44, s44, 32
  s_branch L_vpw
L_vhend:
  v_permlane32_swap_b32 v116, v124
  v_permlane32_swap_b32 v117, v125
  v_permlane32_swap_b32 v118, v126
  v_permlane32_swap_b32 v119, v127
  v_permlane32_swap_b32 v120, v128
  v_permlane32_swap_b32 v121, v129
  v_permlane32_swap_b32 v122, v130
  v_permlane32_swap_b32 v123, v131
  v_add_f32 v132, v116, v124
  v_add_f32 v133, v117, v125
  v_add_f32 v134, v118, v126
  v_add_f32 v135, v119, v127
  v_add_f32 v136, v120, v128
  v_add_f32 v137, v121, v129
  v_add_f32 v138, v122, v130
  v_add_f32 v139, v123, v131
  s_lshl_b32 s48, s49, 12
  v_add_u32 v170, s48, v166
  s_lshl_b32 s48, s49, 2
  s_add_u32 s48, s48, 155696
  v_mov_b32 v172, s48
  v_permlane16_swap_b32 v132, v133
  v_permlane16_swap_b32 v134, v135
  v_permlane16_swap_b32 v136, v137
  v_permlane16_swap_b32 v138, v139
  v_add_f32 v140, v132, v133
  v_add_f32 v141, v134, v135
  v_add_f32 v142, v136, v137
  v_add_f32 v143, v138, v139
  ds_write_b32 v170, v140 offset:0
  ds_write_b32 v170, v141 offset:8
  ds_write_b32 v170, v142 offset:16
  ds_write_b32 v170, v143 offset:24
  v_mov_b32 v116, 0
  v_mov_b32 v117, 0
  v_mov_b32 v118, 0
  v_mov_b32 v119, 0
  v_mov_b32 v120, 0
  v_mov_b32 v121, 0
  v_mov_b32 v122, 0
  v_mov_b32 v123, 0
  v_mov_b32 v124, 0
  v_mov_b32 v125, 0
  v_mov_b32 v126, 0
  v_mov_b32 v127, 0
  v_mov_b32 v128, 0
  v_mov_b32 v129, 0
  v_mov_b32 v130, 0
  v_mov_b32 v131, 0
  s_waitcnt lgkmcnt(0)
  s_mov_b64 exec, 1
  ds_add_u32 v172, v171
  s_mov_b64 exec, -1
  s_add_u32 s49, s49, 1
  s_cmp_lt_u32 s49, 4
  s_cbranch_scc1 L_vhead
  s_mov_b32 s36, s14
  s_and_b32 s37, s15, 0xffff
  s_mov_b32 s38, 32768
  s_mov_b32 s39, 0x20000
  s_lshl_b32 s45, s20, 2
  s_add_u32 s45, s45, 155696
  v_mov_b32 v172, s45
  v_lshlrev_b32 v170, 4, v2
  s_lshl_b32 s45, s20, 12
  s_add_u32 s45, s45, 139264
  v_add_u32 v3, s45, v170
  s_add_u32 s44, s23, s20
  s_lshl_b32 s45, s44, 14
  s_add_u32 s45, s45, 4194304
  s_lshl_b32 s46, s22, 10
  s_add_u32 s46, s46, s45
  s_lshl_b32 s47, s21, 8
  s_lshl_b32 s48, s20, 2
  s_add_u32 s47, s47, s48
  s_add_u32 s47, s47, 6291472
L_wof:
  ds_read_b32 v169, v172
  s_waitcnt lgkmcnt(0)
  v_readfirstlane_b32 s50, v169
  s_cmp_ge_i32 s50, 4
  s_cbranch_scc1 L_wof_ok
  s_sleep 1
  s_add_u32 s97, s97, 1
  s_cmp_gt_u32 s97, 0x100000
  s_cbranch_scc1 L_done
  s_branch L_wof
L_wof_ok:
  ds_read_b128 v[4:7], v3 offset:0
  ds_read_b128 v[8:11], v3 offset:1024
  ds_read_b128 v[12:15], v3 offset:2048
  ds_read_b128 v[16:19], v3 offset:3072
  v_mov_b32 v169, 0
  v_mov_b32 v172, 1
  s_waitcnt lgkmcnt(0)
  v_add_f32 v4, v4, v8
  v_add_f32 v12, v12, v16
  v_add_f32 v5, v5, v9
  v_add_f32 v13, v13, v17
  v_add_f32 v6, v6, v10
  v_add_f32 v14, v14, v18
  v_add_f32 v7, v7, v11
  v_add_f32 v15, v15, v19
  v_add_f32 v4, v4, v12
  v_add_f32 v5, v5, v13
  v_add_f32 v6, v6, v14
  v_add_f32 v7, v7, v15
  buffer_store_dwordx4 v[4:7], v170, s[32:35], s46 offen sc1
  s_waitcnt vmcnt(0)
  s_mov_b64 exec, 1
  buffer_atomic_add v172, v169, s[32:35], s47 offen sc0
  s_mov_b64 exec, -1
  s_waitcnt vmcnt(0)
  v_readfirstlane_b32 s50, v172
  s_cmp_eq_u32 s50, 15
  s_cbranch_scc0 L_cend
  buffer_load_dwordx4 v[4:7], v170, s[32:35], s45 offen offset:0 sc1
  buffer_load_dwordx4 v[8:11], v170, s[32:35], s45 offen offset:1024 sc1
  buffer_load_dwordx4 v[12:15], v170, s[32:35], s45 offen offset:2048 sc1
  buffer_load_dwordx4 v[16:19], v170, s[32:35], s45 offen offset:3072 sc1
  s_add_u32 s45, s45, 4096
  buffer_load_dwordx4 v[20:23], v170, s[32:35], s45 offen offset:0 sc1
  buffer_load_dwordx4 v[24:27], v170, s[32:35], s45 offen offset:1024 sc1
  buffer_load_dwordx4 v[28:31], v170, s[32:35], s45 offen offset:2048 sc1
  buffer_load_dwordx4 v[32:35], v170, s[32:35], s45 offen offset:3072 sc1
  s_add_u32 s45, s45, 4096
  buffer_load_dwordx4 v[36:39], v170, s[32:35], s45 offen offset:0 sc1
  buffer_load_dwordx4 v[40:43], v170, s[32:35], s45 offen offset:1024 sc1
  buffer_load_dwordx4 v[44:47], v170, s[32:35], s45 offen offset:2048 sc1
  buffer_load_dwordx4 v[48:51], v170, s[32:35], s45 offen offset:3072 sc1
  s_add_u32 s45, s45, 4096
  buffer_load_dwordx4 v[52:55], v170, s[32:35], s45 offen offset:0 sc1
  buffer_load_dwordx4 v[56:59], v170, s[32:35], s45 offen offset:1024 sc1
  buffer_load_dwordx4 v[60:63], v170, s[32:35], s45 offen offset:2048 sc1
  buffer_load_dwordx4 v[64:67], v170, s[32:35], s45 offen offset:3072 sc1
  v_lshlrev_b32 v169, 3, v2
  s_lshl_b32 s45, s44, 9
  s_waitcnt vmcnt(0)
  v_add_f32 v4, v4, v36
  v_add_f32 v5, v5, v37
  v_add_f32 v6, v6, v38
  v_add_f32 v7, v7, v39
  v_add_f32 v8, v8, v40
  v_add_f32 v9, v9, v41
  v_add_f32 v10, v10, v42
  v_add_f32 v11, v11, v43
  v_add_f32 v12, v12, v44
  v_add_f32 v13, v13, v45
  v_add_f32 v14, v14, v46
  v_add_f32 v15, v15, v47
  v_add_f32 v16, v16, v48
  v_add_f32 v17, v17, v49
  v_add_f32 v18, v18, v50
  v_add_f32 v19, v19, v51
  v_add_f32 v20, v20, v52
  v_add_f32 v21, v21, v53
  v_add_f32 v22, v22, v54
  v_add_f32 v23, v23, v55
  v_add_f32 v24, v24, v56
  v_add_f32 v25, v25, v57
  v_add_f32 v26, v26, v58
  v_add_f32 v27, v27, v59
  v_add_f32 v28, v28, v60
  v_add_f32 v29, v29, v61
  v_add_f32 v30, v30, v62
  v_add_f32 v31, v31, v63
  v_add_f32 v32, v32, v64
  v_add_f32 v33, v33, v65
  v_add_f32 v34, v34, v66
  v_add_f32 v35, v35, v67
  v_add_f32 v4, v4, v20
  v_add_f32 v5, v5, v21
  v_add_f32 v6, v6, v22
  v_add_f32 v7, v7, v23
  v_add_f32 v8, v8, v24
  v_add_f32 v9, v9, v25
  v_add_f32 v10, v10, v26
  v_add_f32 v11, v11, v27
  v_add_f32 v12, v12, v28
  v_add_f32 v13, v13, v29
  v_add_f32 v14, v14, v30
  v_add_f32 v15, v15, v31
  v_add_f32 v16, v16, v32
  v_add_f32 v17, v17, v33
  v_add_f32 v18, v18, v34
  v_add_f32 v19, v19, v35
  v_add_f32 v4, v4, v12
  v_add_f32 v5, v5, v13
  v_add_f32 v6, v6, v14
  v_add_f32 v7, v7, v15
  v_add_f32 v8, v8, v16
  v_add_f32 v9, v9, v17
  v_add_f32 v10, v10, v18
  v_add_f32 v11, v11, v19
  v_add_f32 v4, v4, v8
  v_add_f32 v5, v5, v9
  v_add_f32 v6, v6, v10
  v_add_f32 v7, v7, v11
  v_cvt_pk_bf16_f32 v8, v4, v5
  v_cvt_pk_bf16_f32 v9, v6, v7
  buffer_store_dwordx2 v[8:9], v169, s[36:39], s45 offen
L_cend:
  s_branch L_done
L_helper:
  v_lshlrev_b32 v10, 2, v2
  v_mov_b32 v4, 0
  v_add_u32 v14, 155648, v10
  ds_write_b32 v14, v4
  v_lshlrev_b32 v3, 4, v2
  v_mov_b32 v5, 1
  s_waitcnt lgkmcnt(0)
  s_barrier
  s_mov_b32 s24, s10
  s_and_b32 s25, s11, 0xffff
  s_mov_b32 s26, 1048576
  s_mov_b32 s27, 0x20000
  s_mov_b32 s28, s12
  s_and_b32 s29, s13, 0xffff
  s_mov_b32 s30, 1048576
  s_mov_b32 s31, 0x20000
  s_mov_b32 s32, s18
  s_and_b32 s33, s19, 0xffff
  s_mov_b32 s34, 8388608
  s_mov_b32 s35, 0x20000
  s_mov_b32 s36, s14
  s_and_b32 s37, s15, 0xffff
  s_mov_b32 s38, 32768
  s_mov_b32 s39, 0x20000
  s_lshl_b32 s58, s21, 8
  s_add_u32 s58, s58, 6291456
  s_lshl_b32 s59, s23, 8
  s_add_u32 s59, s59, 6422528
  s_cmp_lg_u32 s22, 0
  s_cbranch_scc1 L_noreset
  v_mov_b32 v48, 0
  v_mov_b32 v52, -1
  v_mov_b32 v49, 0
  v_mov_b32 v53, -1
  v_mov_b32 v50, 0
  v_mov_b32 v54, -1
  v_mov_b32 v51, 0
  v_mov_b32 v55, -1
  s_mov_b64 exec, 3
  buffer_store_dwordx4 v[48:51], v3, s[32:35], s58 offen sc1
  s_mov_b64 exec, -1
  buffer_store_dwordx4 v[52:55], v3, s[32:35], s59 offen sc1
  s_lshl_b32 s46, s21, 4
  v_mov_b32 v14, s46
  s_waitcnt vmcnt(0)
  s_mov_b64 exec, 1
  global_store_dword v14, v5, s[16:17] sc1
  s_mov_b64 exec, -1
L_noreset:
  s_mov_b32 s40, 65536
  s_lshl_b32 s41, s22, 10
  s_mov_b32 s43, 64
L_edma:
  s_mov_b32 m0, s40
  s_add_u32 s40, s40, 1040
  buffer_load_dwordx4 v3, s[24:27], s41 offen nt lds
  s_add_u32 s41, s41, 16384
  s_waitcnt vmcnt(7)
  s_sub_u32 s43, s43, 1
  s_cmp_lg_u32 s43, 0
  s_cbranch_scc1 L_edma
  s_waitcnt vmcnt(0)
  v_mov_b32 v18, 155728
  ds_write_b32 v18, v5
  v_add_u32 v20, 139264, v3
  v_lshlrev_b32 v23, 3, v2
  v_lshrrev_b32 v21, 4, v2
  v_and_b32 v21, 1, v21
  v_lshlrev_b32 v21, 10, v21
  v_and_b32 v14, 15, v2
  v_lshlrev_b32 v14, 4, v14
  v_add_u32 v21, v21, v14
  v_add_u32 v21, 134144, v21
  v_and_b32 v22, 1, v2
  v_lshlrev_b32 v22, 7, v22
  v_lshrrev_b32 v14, 1, v2
  v_lshlrev_b32 v14, 2, v14
  v_add_u32 v22, v22, v14
  v_mov_b32 v18, 155680
L_s0w:
  ds_read_b32 v14, v18
  s_waitcnt lgkmcnt(0)
  v_readfirstlane_b32 s50, v14
  s_cmp_ge_i32 s50, 4
  s_cbranch_scc1 L_s0w_ok
  s_sleep 4
  s_add_u32 s97, s97, 1
  s_cmp_gt_u32 s97, 0x100000
  s_cbranch_scc1 L_done
  s_branch L_s0w
L_s0w_ok:
  s_mov_b32 s40, 65536
  s_lshl_b32 s41, s22, 10
  s_mov_b32 s43, 64
L_fdma:
  s_mov_b32 m0, s40
  s_add_u32 s40, s40, 1040
  buffer_load_dwordx4 v3, s[28:31], s41 offen nt lds
  s_add_u32 s41, s41, 16384
  s_waitcnt vmcnt(7)
  s_sub_u32 s43, s43, 1
  s_cmp_lg_u32 s43, 0
  s_cbranch_scc1 L_fdma
  s_waitcnt vmcnt(0)
  v_mov_b32 v18, 155732
  ds_write_b32 v18, v5
  s_lshl_b32 s46, s21, 4
  v_mov_b32 v14, s46
L_wgo:
  global_load_dword v15, v14, s[16:17] sc1
  s_waitcnt vmcnt(0)
  v_readfirstlane_b32 s50, v15
  s_cmp_ge_u32 s50, 1
  s_cbranch_scc1 L_wgo_ok
  s_sleep 32
  s_add_u32 s97, s97, 1
  s_cmp_gt_u32 s97, 0x100000
  s_cbranch_scc1 L_done
  s_branch L_wgo
L_wgo_ok:
  v_mov_b32 v18, 155684
L_s1w:
  ds_read_b32 v14, v18
  s_waitcnt lgkmcnt(0)
  v_readfirstlane_b32 s50, v14
  s_cmp_ge_i32 s50, 4
  s_cbranch_scc1 L_s1w_ok
  s_sleep 4
  s_add_u32 s97, s97, 1
  s_cmp_gt_u32 s97, 0x100000
  s_cbranch_scc1 L_done
  s_branch L_s1w
L_s1w_ok:
  ds_read_b128 v[48:51], v21 offset:0
  ds_read_b128 v[52:55], v21 offset:256
  ds_read_b128 v[56:59], v21 offset:512
  ds_read_b128 v[60:63], v21 offset:768
  s_lshl_b32 s45, s21, 1
  s_add_u32 s45, s45, 0
  s_lshl_b32 s45, s45, 13
  s_add_u32 s45, s45, 0
  s_lshl_b32 s46, s22, 9
  s_add_u32 s46, s46, s45
  s_waitcnt lgkmcnt(0)
  v_add_f32 v48, v48, v52
  v_add_f32 v56, v56, v60
  v_add_f32 v49, v49, v53
  v_add_f32 v57, v57, v61
  v_add_f32 v50, v50, v54
  v_add_f32 v58, v58, v62
  v_add_f32 v51, v51, v55
  v_add_f32 v59, v59, v63
  v_add_f32 v48, v48, v56
  v_add_f32 v49, v49, v57
  v_add_f32 v50, v50, v58
  v_add_f32 v51, v51, v59
  s_mov_b32 exec_hi, 0
  buffer_store_dwordx4 v[48:51], v3, s[32:35], s46 offen sc1
  s_mov_b64 exec, -1
  v_mov_b32 v15, 1
  s_waitcnt vmcnt(0)
  s_mov_b64 exec, 1
  buffer_atomic_add v15, v4, s[32:35], s58 offen offset:0 sc0
  s_mov_b64 exec, -1
  s_waitcnt vmcnt(0)
  v_readfirstlane_b32 s50, v15
  s_cmp_eq_u32 s50, 15
  s_cbranch_scc0 L_r0_nl
  buffer_load_dword v48, v10, s[32:35], s45 offen offset:0 sc1
  buffer_load_dword v64, v10, s[32:35], s45 offen offset:256 sc1
  buffer_load_dword v49, v10, s[32:35], s45 offen offset:512 sc1
  buffer_load_dword v65, v10, s[32:35], s45 offen offset:768 sc1
  buffer_load_dword v50, v10, s[32:35], s45 offen offset:1024 sc1
  buffer_load_dword v66, v10, s[32:35], s45 offen offset:1280 sc1
  buffer_load_dword v51, v10, s[32:35], s45 offen offset:1536 sc1
  buffer_load_dword v67, v10, s[32:35], s45 offen offset:1792 sc1
  buffer_load_dword v52, v10, s[32:35], s45 offen offset:2048 sc1
  buffer_load_dword v68, v10, s[32:35], s45 offen offset:2304 sc1
  buffer_load_dword v53, v10, s[32:35], s45 offen offset:2560 sc1
  buffer_load_dword v69, v10, s[32:35], s45 offen offset:2816 sc1
  buffer_load_dword v54, v10, s[32:35], s45 offen offset:3072 sc1
  buffer_load_dword v70, v10, s[32:35], s45 offen offset:3328 sc1
  buffer_load_dword v55, v10, s[32:35], s45 offen offset:3584 sc1
  buffer_load_dword v71, v10, s[32:35], s45 offen offset:3840 sc1
  s_add_u32 s45, s45, 4096
  buffer_load_dword v56, v10, s[32:35], s45 offen offset:0 sc1
  buffer_load_dword v72, v10, s[32:35], s45 offen offset:256 sc1
  buffer_load_dword v57, v10, s[32:35], s45 offen offset:512 sc1
  buffer_load_dword v73, v10, s[32:35], s45 offen offset:768 sc1
  buffer_load_dword v58, v10, s[32:35], s45 offen offset:1024 sc1
  buffer_load_dword v74, v10, s[32:35], s45 offen offset:1280 sc1
  buffer_load_dword v59, v10, s[32:35], s45 offen offset:1536 sc1
  buffer_load_dword v75, v10, s[32:35], s45 offen offset:1792 sc1
  buffer_load_dword v60, v10, s[32:35], s45 offen offset:2048 sc1
  buffer_load_dword v76, v10, s[32:35], s45 offen offset:2304 sc1
  buffer_load_dword v61, v10, s[32:35], s45 offen offset:2560 sc1
  buffer_load_dword v77, v10, s[32:35], s45 offen offset:2816 sc1
  buffer_load_dword v62, v10, s[32:35], s45 offen offset:3072 sc1
  buffer_load_dword v78, v10, s[32:35], s45 offen offset:3328 sc1
  buffer_load_dword v63, v10, s[32:35], s45 offen offset:3584 sc1
  buffer_load_dword v79, v10, s[32:35], s45 offen offset:3840 sc1
  s_waitcnt vmcnt(0)
  v_add_f32 v48, v48, v56
  v_add_f32 v49, v49, v57
  v_add_f32 v50, v50, v58
  v_add_f32 v51, v51, v59
  v_add_f32 v52, v52, v60
  v_add_f32 v53, v53, v61
  v_add_f32 v54, v54, v62
  v_add_f32 v55, v55, v63
  v_add_f32 v48, v48, v52
  v_add_f32 v49, v49, v53
  v_add_f32 v50, v50, v54
  v_add_f32 v51, v51, v55
  v_add_f32 v48, v48, v50
  v_add_f32 v49, v49, v51
  v_add_f32 v48, v48, v49
  v_mul_f32 v13, 0x3db8aa3b, v48
  v_mov_b32 v89, v13
  s_nop 1
  v_max_f32_dpp v89, v89, v89 row_ror:8 row_mask:0xf bank_mask:0xf
  s_nop 1
  v_max_f32_dpp v89, v89, v89 row_ror:4 row_mask:0xf bank_mask:0xf
  s_nop 1
  v_max_f32_dpp v89, v89, v89 row_ror:2 row_mask:0xf bank_mask:0xf
  s_nop 1
  v_max_f32_dpp v89, v89, v89 row_ror:1 row_mask:0xf bank_mask:0xf
  v_mov_b32 v90, v89
  v_mov_b32 v91, v89
  s_nop 1
  v_permlane16_swap_b32 v90, v91
  v_max_f32 v89, v90, v91
  s_nop 0
  v_mov_b32 v90, v89
  v_mov_b32 v91, v89
  s_nop 1
  v_permlane32_swap_b32 v90, v91
  v_max_f32 v89, v90, v91
  v_sub_f32 v13, v13, v89
  v_exp_f32 v13, v13
  s_nop 0
  v_mov_b32 v89, v13
  s_nop 1
  v_add_f32_dpp v89, v89, v89 row_ror:8 row_mask:0xf bank_mask:0xf
  s_nop 1
  v_add_f32_dpp v89, v89, v89 row_ror:4 row_mask:0xf bank_mask:0xf
  s_nop 1
  v_add_f32_dpp v89, v89, v89 row_ror:2 row_mask:0xf bank_mask:0xf
  s_nop 1
  v_add_f32_dpp v89, v89, v89 row_ror:1 row_mask:0xf bank_mask:0xf
  v_mov_b32 v90, v89
  v_mov_b32 v91, v89
  s_nop 1
  v_permlane16_swap_b32 v90, v91
  v_add_f32 v89, v90, v91
  s_nop 0
  v_mov_b32 v90, v89
  v_mov_b32 v91, v89
  s_nop 1
  v_permlane32_swap_b32 v90, v91
  v_add_f32 v89, v90, v91
  v_rcp_f32 v89, v89
  s_nop 0
  v_mul_f32 v13, v13, v89
  v_cvt_pk_bf16_f32 v88, v13, v13
  v_lshlrev_b32 v88, 16, v88
  v_sub_f32 v89, v13, v88
  s_nop 1
  v_mov_b32_dpp v90, v13 quad_perm:[1,0,3,2] row_mask:0xf bank_mask:0xf
  v_mov_b32_dpp v91, v89 quad_perm:[1,0,3,2] row_mask:0xf bank_mask:0xf
  v_cvt_pk_bf16_f32 v92, v13, v90
  v_cvt_pk_bf16_f32 v93, v91, v89
  v_and_b32 v94, 1, v2
  v_cmp_eq_u32 vcc, 1, v94
  s_nop 1
  v_cndmask_b32 v92, v92, v93, vcc
  v_mov_b32 v93, 0x7fc07fc0
  v_cmp_eq_u32 vcc, -1, v92
  s_nop 1
  v_cndmask_b32 v96, v92, v93, vcc
  v_add_f32 v64, v64, v72
  v_add_f32 v65, v65, v73
  v_add_f32 v66, v66, v74
  v_add_f32 v67, v67, v75
  v_add_f32 v68, v68, v76
  v_add_f32 v69, v69, v77
  v_add_f32 v70, v70, v78
  v_add_f32 v71, v71, v79
  v_add_f32 v64, v64, v68
  v_add_f32 v65, v65, v69
  v_add_f32 v66, v66, v70
  v_add_f32 v67, v67, v71
  v_add_f32 v64, v64, v66
  v_add_f32 v65, v65, v67
  v_add_f32 v64, v64, v65
  v_mul_f32 v13, 0x3db8aa3b, v64
  v_mov_b32 v89, v13
  s_nop 1
  v_max_f32_dpp v89, v89, v89 row_ror:8 row_mask:0xf bank_mask:0xf
  s_nop 1
  v_max_f32_dpp v89, v89, v89 row_ror:4 row_mask:0xf bank_mask:0xf
  s_nop 1
  v_max_f32_dpp v89, v89, v89 row_ror:2 row_mask:0xf bank_mask:0xf
  s_nop 1
  v_max_f32_dpp v89, v89, v89 row_ror:1 row_mask:0xf bank_mask:0xf
  v_mov_b32 v90, v89
  v_mov_b32 v91, v89
  s_nop 1
  v_permlane16_swap_b32 v90, v91
  v_max_f32 v89, v90, v91
  s_nop 0
  v_mov_b32 v90, v89
  v_mov_b32 v91, v89
  s_nop 1
  v_permlane32_swap_b32 v90, v91
  v_max_f32 v89, v90, v91
  v_sub_f32 v13, v13, v89
  v_exp_f32 v13, v13
  s_nop 0
  v_mov_b32 v89, v13
  s_nop 1
  v_add_f32_dpp v89, v89, v89 row_ror:8 row_mask:0xf bank_mask:0xf
  s_nop 1
  v_add_f32_dpp v89, v89, v89 row_ror:4 row_mask:0xf bank_mask:0xf
  s_nop 1
  v_add_f32_dpp v89, v89, v89 row_ror:2 row_mask:0xf bank_mask:0xf
  s_nop 1
  v_add_f32_dpp v89, v89, v89 row_ror:1 row_mask:0xf bank_mask:0xf
  v_mov_b32 v90, v89
  v_mov_b32 v91, v89
  s_nop 1
  v_permlane16_swap_b32 v90, v91
  v_add_f32 v89, v90, v91
  s_nop 0
  v_mov_b32 v90, v89
  v_mov_b32 v91, v89
  s_nop 1
  v_permlane32_swap_b32 v90, v91
  v_add_f32 v89, v90, v91
  v_rcp_f32 v89, v89
  s_nop 0
  v_mul_f32 v13, v13, v89
  v_cvt_pk_bf16_f32 v88, v13, v13
  v_lshlrev_b32 v88, 16, v88
  v_sub_f32 v89, v13, v88
  s_nop 1
  v_mov_b32_dpp v90, v13 quad_perm:[1,0,3,2] row_mask:0xf bank_mask:0xf
  v_mov_b32_dpp v91, v89 quad_perm:[1,0,3,2] row_mask:0xf bank_mask:0xf
  v_cvt_pk_bf16_f32 v92, v13, v90
  v_cvt_pk_bf16_f32 v93, v91, v89
  v_and_b32 v94, 1, v2
  v_cmp_eq_u32 vcc, 1, v94
  s_nop 1
  v_cndmask_b32 v92, v92, v93, vcc
  v_mov_b32 v93, 0x7fc07fc0
  v_cmp_eq_u32 vcc, -1, v92
  s_nop 1
  v_cndmask_b32 v97, v92, v93, vcc
  buffer_store_dword v96, v22, s[32:35], s59 offen offset:0 sc1
  buffer_store_dword v97, v22, s[32:35], s59 offen offset:256 sc1
L_r0_nl:
  v_mov_b32 v18, 155688
L_s2w:
  ds_read_b32 v14, v18
  s_waitcnt lgkmcnt(0)
  v_readfirstlane_b32 s50, v14
  s_cmp_ge_i32 s50, 4
  s_cbranch_scc1 L_s2w_ok
  s_sleep 4
  s_add_u32 s97, s97, 1
  s_cmp_gt_u32 s97, 0x100000
  s_cbranch_scc1 L_done
  s_branch L_s2w
L_s2w_ok:
L_p0:
  buffer_load_dwordx2 v[48:49], v23, s[32:35], s59 offen offset:0 sc1
  s_waitcnt vmcnt(0)
  v_cmp_eq_u32 vcc, -1, v48
  v_cmp_eq_u32 s[46:47], -1, v49
  s_nop 1
  s_or_b64 vcc, vcc, s[46:47]
  s_cmp_eq_u64 vcc, 0
  s_cbranch_scc1 L_p0_ok
  s_sleep 16
  s_add_u32 s97, s97, 1
  s_cmp_gt_u32 s97, 0x100000
  s_cbranch_scc1 L_done
  s_branch L_p0
L_p0_ok:
  v_add_u32 v14, 138240, v23
  ds_write_b64 v14, v[48:49]
  v_mov_b32 v18, 155712
  s_waitcnt lgkmcnt(0)
  ds_write_b32 v18, v5
  ds_write_b32 v18, v5 offset:4
  v_mov_b32 v18, 155692
L_s3w:
  ds_read_b32 v14, v18
  s_waitcnt lgkmcnt(0)
  v_readfirstlane_b32 s50, v14
  s_cmp_ge_i32 s50, 4
  s_cbranch_scc1 L_s3w_ok
  s_sleep 4
  s_add_u32 s97, s97, 1
  s_cmp_gt_u32 s97, 0x100000
  s_cbranch_scc1 L_done
  s_branch L_s3w
L_s3w_ok:
  ds_read_b128 v[48:51], v21 offset:2048
  ds_read_b128 v[52:55], v21 offset:2304
  ds_read_b128 v[56:59], v21 offset:2560
  ds_read_b128 v[60:63], v21 offset:2816
  s_lshl_b32 s45, s21, 1
  s_add_u32 s45, s45, 1
  s_lshl_b32 s45, s45, 13
  s_add_u32 s45, s45, 0
  s_lshl_b32 s46, s22, 9
  s_add_u32 s46, s46, s45
  s_waitcnt lgkmcnt(0)
  v_add_f32 v48, v48, v52
  v_add_f32 v56, v56, v60
  v_add_f32 v49, v49, v53
  v_add_f32 v57, v57, v61
  v_add_f32 v50, v50, v54
  v_add_f32 v58, v58, v62
  v_add_f32 v51, v51, v55
  v_add_f32 v59, v59, v63
  v_add_f32 v48, v48, v56
  v_add_f32 v49, v49, v57
  v_add_f32 v50, v50, v58
  v_add_f32 v51, v51, v59
  s_mov_b32 exec_hi, 0
  buffer_store_dwordx4 v[48:51], v3, s[32:35], s46 offen sc1
  s_mov_b64 exec, -1
  v_mov_b32 v15, 1
  s_waitcnt vmcnt(0)
  s_mov_b64 exec, 1
  buffer_atomic_add v15, v4, s[32:35], s58 offen offset:4 sc0
  s_mov_b64 exec, -1
  s_waitcnt vmcnt(0)
  v_readfirstlane_b32 s50, v15
  s_cmp_eq_u32 s50, 15
  s_cbranch_scc0 L_r1_nl
  buffer_load_dword v48, v10, s[32:35], s45 offen offset:0 sc1
  buffer_load_dword v64, v10, s[32:35], s45 offen offset:256 sc1
  buffer_load_dword v49, v10, s[32:35], s45 offen offset:512 sc1
  buffer_load_dword v65, v10, s[32:35], s45 offen offset:768 sc1
  buffer_load_dword v50, v10, s[32:35], s45 offen offset:1024 sc1
  buffer_load_dword v66, v10, s[32:35], s45 offen offset:1280 sc1
  buffer_load_dword v51, v10, s[32:35], s45 offen offset:1536 sc1
  buffer_load_dword v67, v10, s[32:35], s45 offen offset:1792 sc1
  buffer_load_dword v52, v10, s[32:35], s45 offen offset:2048 sc1
  buffer_load_dword v68, v10, s[32:35], s45 offen offset:2304 sc1
  buffer_load_dword v53, v10, s[32:35], s45 offen offset:2560 sc1
  buffer_load_dword v69, v10, s[32:35], s45 offen offset:2816 sc1
  buffer_load_dword v54, v10, s[32:35], s45 offen offset:3072 sc1
  buffer_load_dword v70, v10, s[32:35], s45 offen offset:3328 sc1
  buffer_load_dword v55, v10, s[32:35], s45 offen offset:3584 sc1
  buffer_load_dword v71, v10, s[32:35], s45 offen offset:3840 sc1
  s_add_u32 s45, s45, 4096
  buffer_load_dword v56, v10, s[32:35], s45 offen offset:0 sc1
  buffer_load_dword v72, v10, s[32:35], s45 offen offset:256 sc1
  buffer_load_dword v57, v10, s[32:35], s45 offen offset:512 sc1
  buffer_load_dword v73, v10, s[32:35], s45 offen offset:768 sc1
  buffer_load_dword v58, v10, s[32:35], s45 offen offset:1024 sc1
  buffer_load_dword v74, v10, s[32:35], s45 offen offset:1280 sc1
  buffer_load_dword v59, v10, s[32:35], s45 offen offset:1536 sc1
  buffer_load_dword v75, v10, s[32:35], s45 offen offset:1792 sc1
  buffer_load_dword v60, v10, s[32:35], s45 offen offset:2048 sc1
  buffer_load_dword v76, v10, s[32:35], s45 offen offset:2304 sc1
  buffer_load_dword v61, v10, s[32:35], s45 offen offset:2560 sc1
  buffer_load_dword v77, v10, s[32:35], s45 offen offset:2816 sc1
  buffer_load_dword v62, v10, s[32:35], s45 offen offset:3072 sc1
  buffer_load_dword v78, v10, s[32:35], s45 offen offset:3328 sc1
  buffer_load_dword v63, v10, s[32:35], s45 offen offset:3584 sc1
  buffer_load_dword v79, v10, s[32:35], s45 offen offset:3840 sc1
  s_waitcnt vmcnt(0)
  v_add_f32 v48, v48, v56
  v_add_f32 v49, v49, v57
  v_add_f32 v50, v50, v58
  v_add_f32 v51, v51, v59
  v_add_f32 v52, v52, v60
  v_add_f32 v53, v53, v61
  v_add_f32 v54, v54, v62
  v_add_f32 v55, v55, v63
  v_add_f32 v48, v48, v52
  v_add_f32 v49, v49, v53
  v_add_f32 v50, v50, v54
  v_add_f32 v51, v51, v55
  v_add_f32 v48, v48, v50
  v_add_f32 v49, v49, v51
  v_add_f32 v48, v48, v49
  v_mul_f32 v13, 0x3db8aa3b, v48
  v_mov_b32 v89, v13
  s_nop 1
  v_max_f32_dpp v89, v89, v89 row_ror:8 row_mask:0xf bank_mask:0xf
  s_nop 1
  v_max_f32_dpp v89, v89, v89 row_ror:4 row_mask:0xf bank_mask:0xf
  s_nop 1
  v_max_f32_dpp v89, v89, v89 row_ror:2 row_mask:0xf bank_mask:0xf
  s_nop 1
  v_max_f32_dpp v89, v89, v89 row_ror:1 row_mask:0xf bank_mask:0xf
  v_mov_b32 v90, v89
  v_mov_b32 v91, v89
  s_nop 1
  v_permlane16_swap_b32 v90, v91
  v_max_f32 v89, v90, v91
  s_nop 0
  v_mov_b32 v90, v89
  v_mov_b32 v91, v89
  s_nop 1
  v_permlane32_swap_b32 v90, v91
  v_max_f32 v89, v90, v91
  v_sub_f32 v13, v13, v89
  v_exp_f32 v13, v13
  s_nop 0
  v_mov_b32 v89, v13
  s_nop 1
  v_add_f32_dpp v89, v89, v89 row_ror:8 row_mask:0xf bank_mask:0xf
  s_nop 1
  v_add_f32_dpp v89, v89, v89 row_ror:4 row_mask:0xf bank_mask:0xf
  s_nop 1
  v_add_f32_dpp v89, v89, v89 row_ror:2 row_mask:0xf bank_mask:0xf
  s_nop 1
  v_add_f32_dpp v89, v89, v89 row_ror:1 row_mask:0xf bank_mask:0xf
  v_mov_b32 v90, v89
  v_mov_b32 v91, v89
  s_nop 1
  v_permlane16_swap_b32 v90, v91
  v_add_f32 v89, v90, v91
  s_nop 0
  v_mov_b32 v90, v89
  v_mov_b32 v91, v89
  s_nop 1
  v_permlane32_swap_b32 v90, v91
  v_add_f32 v89, v90, v91
  v_rcp_f32 v89, v89
  s_nop 0
  v_mul_f32 v13, v13, v89
  v_cvt_pk_bf16_f32 v88, v13, v13
  v_lshlrev_b32 v88, 16, v88
  v_sub_f32 v89, v13, v88
  s_nop 1
  v_mov_b32_dpp v90, v13 quad_perm:[1,0,3,2] row_mask:0xf bank_mask:0xf
  v_mov_b32_dpp v91, v89 quad_perm:[1,0,3,2] row_mask:0xf bank_mask:0xf
  v_cvt_pk_bf16_f32 v92, v13, v90
  v_cvt_pk_bf16_f32 v93, v91, v89
  v_and_b32 v94, 1, v2
  v_cmp_eq_u32 vcc, 1, v94
  s_nop 1
  v_cndmask_b32 v92, v92, v93, vcc
  v_mov_b32 v93, 0x7fc07fc0
  v_cmp_eq_u32 vcc, -1, v92
  s_nop 1
  v_cndmask_b32 v96, v92, v93, vcc
  v_add_f32 v64, v64, v72
  v_add_f32 v65, v65, v73
  v_add_f32 v66, v66, v74
  v_add_f32 v67, v67, v75
  v_add_f32 v68, v68, v76
  v_add_f32 v69, v69, v77
  v_add_f32 v70, v70, v78
  v_add_f32 v71, v71, v79
  v_add_f32 v64, v64, v68
  v_add_f32 v65, v65, v69
  v_add_f32 v66, v66, v70
  v_add_f32 v67, v67, v71
  v_add_f32 v64, v64, v66
  v_add_f32 v65, v65, v67
  v_add_f32 v64, v64, v65
  v_mul_f32 v13, 0x3db8aa3b, v64
  v_mov_b32 v89, v13
  s_nop 1
  v_max_f32_dpp v89, v89, v89 row_ror:8 row_mask:0xf bank_mask:0xf
  s_nop 1
  v_max_f32_dpp v89, v89, v89 row_ror:4 row_mask:0xf bank_mask:0xf
  s_nop 1
  v_max_f32_dpp v89, v89, v89 row_ror:2 row_mask:0xf bank_mask:0xf
  s_nop 1
  v_max_f32_dpp v89, v89, v89 row_ror:1 row_mask:0xf bank_mask:0xf
  v_mov_b32 v90, v89
  v_mov_b32 v91, v89
  s_nop 1
  v_permlane16_swap_b32 v90, v91
  v_max_f32 v89, v90, v91
  s_nop 0
  v_mov_b32 v90, v89
  v_mov_b32 v91, v89
  s_nop 1
  v_permlane32_swap_b32 v90, v91
  v_max_f32 v89, v90, v91
  v_sub_f32 v13, v13, v89
  v_exp_f32 v13, v13
  s_nop 0
  v_mov_b32 v89, v13
  s_nop 1
  v_add_f32_dpp v89, v89, v89 row_ror:8 row_mask:0xf bank_mask:0xf
  s_nop 1
  v_add_f32_dpp v89, v89, v89 row_ror:4 row_mask:0xf bank_mask:0xf
  s_nop 1
  v_add_f32_dpp v89, v89, v89 row_ror:2 row_mask:0xf bank_mask:0xf
  s_nop 1
  v_add_f32_dpp v89, v89, v89 row_ror:1 row_mask:0xf bank_mask:0xf
  v_mov_b32 v90, v89
  v_mov_b32 v91, v89
  s_nop 1
  v_permlane16_swap_b32 v90, v91
  v_add_f32 v89, v90, v91
  s_nop 0
  v_mov_b32 v90, v89
  v_mov_b32 v91, v89
  s_nop 1
  v_permlane32_swap_b32 v90, v91
  v_add_f32 v89, v90, v91
  v_rcp_f32 v89, v89
  s_nop 0
  v_mul_f32 v13, v13, v89
  v_cvt_pk_bf16_f32 v88, v13, v13
  v_lshlrev_b32 v88, 16, v88
  v_sub_f32 v89, v13, v88
  s_nop 1
  v_mov_b32_dpp v90, v13 quad_perm:[1,0,3,2] row_mask:0xf bank_mask:0xf
  v_mov_b32_dpp v91, v89 quad_perm:[1,0,3,2] row_mask:0xf bank_mask:0xf
  v_cvt_pk_bf16_f32 v92, v13, v90
  v_cvt_pk_bf16_f32 v93, v91, v89
  v_and_b32 v94, 1, v2
  v_cmp_eq_u32 vcc, 1, v94
  s_nop 1
  v_cndmask_b32 v92, v92, v93, vcc
  v_mov_b32 v93, 0x7fc07fc0
  v_cmp_eq_u32 vcc, -1, v92
  s_nop 1
  v_cndmask_b32 v97, v92, v93, vcc
  buffer_store_dword v96, v22, s[32:35], s59 offen offset:512 sc1
  buffer_store_dword v97, v22, s[32:35], s59 offen offset:768 sc1
L_r1_nl:
  v_mov_b32 v18, 155696
L_wo0:
  ds_read_b32 v14, v18
  s_waitcnt lgkmcnt(0)
  v_readfirstlane_b32 s50, v14
  s_cmp_ge_i32 s50, 4
  s_cbranch_scc1 L_wo0_ok
  s_sleep 8
  s_add_u32 s97, s97, 1
  s_cmp_gt_u32 s97, 0x100000
  s_cbranch_scc1 L_done
  s_branch L_wo0
L_wo0_ok:
L_p1:
  buffer_load_dwordx2 v[48:49], v23, s[32:35], s59 offen offset:512 sc1
  s_waitcnt vmcnt(0)
  v_cmp_eq_u32 vcc, -1, v48
  v_cmp_eq_u32 s[46:47], -1, v49
  s_nop 1
  s_or_b64 vcc, vcc, s[46:47]
  s_cmp_eq_u64 vcc, 0
  s_cbranch_scc1 L_p1_ok
  s_sleep 16
  s_add_u32 s97, s97, 1
  s_cmp_gt_u32 s97, 0x100000
  s_cbranch_scc1 L_done
  s_branch L_p1
L_p1_ok:
  v_add_u32 v14, 138752, v23
  ds_write_b64 v14, v[48:49]
  v_mov_b32 v18, 155720
  s_waitcnt lgkmcnt(0)
  ds_write_b32 v18, v5
  ds_write_b32 v18, v5 offset:4
  v_mov_b32 v18, 155740
L_ww3:
  ds_read_b32 v14, v18
  s_waitcnt lgkmcnt(0)
  v_readfirstlane_b32 s50, v14
  s_cmp_ge_i32 s50, 4
  s_cbranch_scc1 L_ww3_ok
  s_sleep 8
  s_add_u32 s97, s97, 1
  s_cmp_gt_u32 s97, 0x100000
  s_cbranch_scc1 L_done
  s_branch L_ww3
L_ww3_ok:
  s_mul_i32 s45, s21, 16384
  s_mul_i32 s46, s22, 1024
  s_add_u32 s45, s45, s46
  s_add_u32 s45, s45, 2097152
  v_add_u32 v14, 65536, v3
  ds_read_b128 v[48:51], v14
  s_waitcnt lgkmcnt(0)
  buffer_store_dwordx4 v[48:51], v3, s[32:35], s45 offen offset:0 sc1
  s_mov_b64 exec, -1
  v_mov_b32 v15, 1
  s_waitcnt vmcnt(0)
  s_mov_b64 exec, 1
  buffer_atomic_add v15, v4, s[32:35], s58 offen offset:8 sc0
  s_mov_b64 exec, -1
  s_waitcnt vmcnt(0)
  v_readfirstlane_b32 s50, v15
  s_cmp_eq_u32 s50, 15
  s_cbranch_scc1 L_wall_ok
L_wall:
  s_sleep 32
  s_add_u32 s97, s97, 1
  s_cmp_gt_u32 s97, 0x100000
  s_cbranch_scc1 L_done
  buffer_load_dword v15, v4, s[32:35], s58 offen offset:8 sc1
  s_waitcnt vmcnt(0)
  v_readfirstlane_b32 s50, v15
  s_cmp_ge_u32 s50, 16
  s_cbranch_scc0 L_wall
L_wall_ok:
  s_mov_b32 s42, 0
  v_mov_b32 v18, 155656
L_tk:
  s_add_u32 s43, s42, 59
L_tkw:
  ds_read_b32 v14, v18
  s_waitcnt lgkmcnt(0)
  v_readfirstlane_b32 s50, v14
  s_cmp_ge_i32 s50, s43
  s_cbranch_scc1 L_tkw_ok
  s_sleep 2
  s_add_u32 s97, s97, 1
  s_cmp_gt_u32 s97, 0x100000
  s_cbranch_scc1 L_done
  s_branch L_tkw
L_tkw_ok:
  v_mov_b32 v15, 1
  s_mov_b64 exec, 1
  buffer_atomic_add v15, v4, s[32:35], s58 offen offset:12 sc0
  s_mov_b64 exec, -1
  s_and_b32 s43, s42, 3
  s_lshl_b32 s43, s43, 3
  s_add_u32 s43, s43, 155744
  v_mov_b32 v14, s43
  s_add_u32 s42, s42, 1
  v_mov_b32 v49, s42
  s_waitcnt vmcnt(0)
  v_mov_b32 v48, v15
  s_mov_b64 exec, 1
  ds_write_b64 v14, v[48:49]
  s_mov_b64 exec, -1
  v_readfirstlane_b32 s50, v15
  s_cmp_lt_u32 s50, 64
  s_cbranch_scc1 L_tk
L_done:
  s_endpgm
.section .rodata,"a"
.p2align 6
.amdhsa_kernel standalone__low_rank_proj_linformer__decode_kernel
  .amdhsa_next_free_vgpr 176
  .amdhsa_next_free_sgpr 102
  .amdhsa_accum_offset 176
  .amdhsa_group_segment_fixed_size 0
  .amdhsa_kernarg_size 64
  .amdhsa_float_denorm_mode_32 3
  .amdhsa_float_denorm_mode_16_64 3
  .amdhsa_user_sgpr_count 2
  .amdhsa_user_sgpr_kernarg_segment_ptr 1
  .amdhsa_system_sgpr_workgroup_id_x 1
.end_amdhsa_kernel
```
